```python
import torch

def _softmax(x, axis=-1):
    return torch.softmax(x, dim=axis)
def _gelu(x):
    return torch.nn.functional.gelu(x, approximate="tanh")
def _silu(x):
    return torch.nn.functional.silu(x)
def _sigmoid(x):
    return torch.sigmoid(x)
def _layernorm(x, axis=-1, eps=1e-5):
    m = x.mean(dim=axis, keepdim=True)
    v = x.var(dim=axis, keepdim=True, unbiased=False)
    return (x - m) / torch.sqrt(v + eps)
def _scatter_add(tgt, idx, src, axis=0):
    return tgt.clone().index_add_(axis, idx, src)
def _segment_sum(src, seg, n):
    out = torch.zeros((n,) + src.shape[1:], dtype=src.dtype)
    return out.index_add_(0, seg, src)
def _pad(x, pw):
    flat = tuple(v for pair in reversed(pw) for v in pair)
    return torch.nn.functional.pad(x, flat)

kernel_name = 'parallel_sum__ssm_conv_s4d__glu_gated_glu__prompt'

def setup_inputs():

    _w = (lambda a: (lambda t: t.to(torch.bfloat16) if t.is_floating_point() else t)(torch.as_tensor(a)))
    def _A_setup():
        Bsz, L, D, N = 1, 2048, 640, 192
        return {
            "u": _w((lambda *s: torch.randn(*s, dtype=torch.bfloat16) * 0.05)(Bsz, L, D)),
            "log_A_real": _w((lambda *s: torch.randn(*s, dtype=torch.bfloat16) * 3.2)(D, N) * 0.5),
            "A_imag": _w((lambda *s: torch.randn(*s, dtype=torch.bfloat16) * 0.1)(D, N) * 3.14),
            "C_real": _w((lambda *s: torch.randn(*s, dtype=torch.bfloat16) * 1.6)(D, N) / N ** 0.5),
            "C_imag": _w((lambda *s: torch.randn(*s, dtype=torch.bfloat16) * 1.6)(D, N) / N ** 0.5),
            "log_dt": _w((lambda *s: torch.randn(*s, dtype=torch.bfloat16) * 0.1)(D) * 0.5 - 4.0),
            "D_skip": _w((lambda *s: torch.randn(*s, dtype=torch.bfloat16) * 0.2)(D)),
        }
    _A_in = _A_setup()

    def _B_setup():
        B, S, D, F = 1, 2048, 640, 1536
        return {
            "x": _w((lambda *s: torch.randn(*s, dtype=torch.bfloat16) * 0.05)(B, S, D)),
            "w_gate": _w((lambda *s: torch.randn(*s, dtype=torch.bfloat16) * 0.05)(D, F)),
            "w_up": _w((lambda *s: torch.randn(*s, dtype=torch.bfloat16) * 0.05)(D, F)),
            "w_down": _w((lambda *s: torch.randn(*s, dtype=torch.bfloat16) * 0.05)(F, D)),
        }
    _B_in = _B_setup()

    return {
        "A_u": _A_in["u"],
        "A_log_A_real": _A_in["log_A_real"],
        "A_A_imag": _A_in["A_imag"],
        "A_C_real": _A_in["C_real"],
        "A_C_imag": _A_in["C_imag"],
        "A_log_dt": _A_in["log_dt"],
        "A_D_skip": _A_in["D_skip"],
        "B_x": _B_in["x"],
        "B_w_gate": _B_in["w_gate"],
        "B_w_up": _B_in["w_up"],
        "B_w_down": _B_in["w_down"],
    }

def reference(A_u, A_log_A_real, A_A_imag, A_C_real, A_C_imag, A_log_dt, A_D_skip, B_x, B_w_gate, B_w_up, B_w_down):
    def _A_ref(u, log_A_real, A_imag, C_real, C_imag, log_dt, D_skip):
        L = u.shape[1]
        dt = torch.exp(log_dt)
        A = -torch.exp(log_A_real) + 1j * A_imag
        C = (C_real + 1j * C_imag) * dt[:, None]
        pos = (lambda x, dt: x.to(dt))(torch.arange(L), log_dt.dtype)
        P = torch.exp((A * dt[:, None])[:, :, None] * pos[None, None, :])
        K = 2.0 * torch.einsum("dn,dnl->dl", C, P).real
        L2 = 2 * L
        u_t = (lambda x, *d: x.permute(*d))(u, 0, 2, 1)
        Kf = (lambda x, *a, **k: torch.fft.rfft(x.float(), *a, **k))(K, L2)
        Uf = (lambda x, *a, **k: torch.fft.rfft(x.float(), *a, **k))(u_t, L2)
        y = (lambda x, *a, **k: torch.fft.irfft(x, *a, **k).to(torch.bfloat16))(Uf * Kf[None, :, :], L2)[:, :, :L]
        y = (lambda x, *d: x.permute(*d))(y, 0, 2, 1)
        return y + u * D_skip[None, None, :]

    def _B_ref(x, w_gate, w_up, w_down):
        g = torch.einsum("bsd,df->bsf", x, w_gate)
        u = torch.einsum("bsd,df->bsf", x, w_up)
        h = _sigmoid(g) * u
        return torch.einsum("bsf,fd->bsd", h, w_down)

    x = A_u
    xn = _layernorm(x, axis=-1)
    return x + _A_ref(xn, A_log_A_real, A_A_imag, A_C_real, A_C_imag, A_log_dt, A_D_skip) + _B_ref(xn, B_w_gate, B_w_up, B_w_down)
```

```asm
; @launch kernel=k1_kernel grid=(256,1,1) block=(768,1,1) lds=153408
; @launch kernel=k2_kernel grid=(256,1,1) block=(512,1,1) lds=152960
.amdgcn_target "amdgcn-amd-amdhsa--gfx950"
.text
.globl k1_kernel
.p2align 8
.type k1_kernel,@function
k1_kernel:
    s_cmp_ge_u32 s2, 256
    s_cbranch_scc1 L1end
    v_lshrrev_b32 v1, 6, v0
    v_and_b32 v0, 63, v0
    v_readfirstlane_b32 s3, v1
    v_lshlrev_b32 v1, 4, v0
    s_cmp_lg_u32 s3, 3
    s_cbranch_scc1 L1nz
    v_mov_b32 v4, 0
    v_mov_b32 v5, 0
    v_mov_b32 v6, 0
    v_mov_b32_e64 v7, 0
    v_add_u32 v2, 149312, v1
    ds_write_b128 v2, v[4:7]
    ds_write_b128 v2, v[4:7] offset:1024
    ds_write_b128 v2, v[4:7] offset:2048
    ds_write_b128 v2, v[4:7] offset:3072
    s_waitcnt lgkmcnt(0)
L1nz:
    s_nop 0
    s_load_dwordx16 s[32:47], s[0:1], 0
    s_load_dwordx8 s[48:55], s[0:1], 64
    s_load_dwordx4 s[56:59], s[0:1], 96
    s_cmp_lg_u32 s3, 7
    s_cbranch_scc1 L1nopf
    s_getpc_b64 s[20:21]
L1pc:
    s_lshr_b32 s64, s2, 3
    s_lshl_b32 s64, s64, 10
    s_min_u32 s64, s64, L1end-k1_kernel-1024
    s_sub_u32 s20, s20, L1pc-k1_kernel
    s_subb_u32 s21, s21, 0
    v_add_u32 v10, s64, v1
    global_load_dwordx4 v[16:19], v10, s[20:21]
L1nopf:
    s_and_b32 s60, s2, 1
    s_bfe_u32 s61, s2, 0x20001
    s_bfe_u32 s62, s2, 0x30003
    s_lshr_b32 s63, s2, 6
    s_lshl_b32 s4, s60, 3
    s_add_u32 s4, s4, s62
    s_lshl_b32 s5, s61, 2
    s_add_u32 s5, s5, s63
    s_mov_b32 s95, s3
    s_mov_b32 s93, 0
    s_barrier
    s_cmp_ge_u32 s3, 3
    s_cbranch_scc1 L1notload
    s_setprio 2
    v_min_u32 v8, 5, v0
    v_lshlrev_b32 v8, 8, v8
    v_add_u32 v8, 149312, v8
    v_min_u32 v20, 43, v0
    v_mul_u32_u24 v21, 5958, v20
    v_lshrrev_b32 v21, 16, v21
    v_mul_u32_u24 v22, 11, v21
    v_sub_u32 v22, v20, v22
    s_cmp_eq_u32 s3, 2
    s_cselect_b32 s64, 9, 10
    v_min_u32 v22, s64, v22
    v_lshlrev_b32_e64 v21, 8, v21
    v_lshl_add_u32 v9, v22, 3, v21
    s_mul_i32 s64, s3, 88
    s_add_u32 s64, s64, 152384
    v_add_u32 v9, s64, v9
    s_mov_b32 s26, 0
    s_cmp_eq_u32 s3, 0
    s_cbranch_scc0 L1ldW
    v_lshrrev_b32 v20, 3, v0
    v_and_b32 v21, 7, v0
    v_lshrrev_b32 v22, 4, v0
    v_xor_b32 v21, v21, v22
    v_mul_u32_u24 v20, 1280, v20
    v_lshl_add_u32 v4, v21, 4, v20
    v_xor_b32_e64 v21, 4, v21
    v_lshl_add_u32 v5, v21, 4, v20
    v_add_u32 v5, 9216, v5
    v_add_u32 v6, 18432, v4
    v_add_u32 v7, 18432, v5
    s_mul_i32 s64, s4, 163840
    s_mov_b32 s27, 0
    s_waitcnt lgkmcnt(0)
    s_add_u32 s8, s32, s64
    s_addc_u32 s9, s33, 0
    s_mov_b32 s10, 163840
    s_mov_b32 s11, 0x20000
    s_mov_b32 s29, 123264
    s_add_u32 s74, s63, 0
    s_and_b32 s74, s74, 3
    s_mul_i32 s66, s74, 4096
    s_mul_i32 s70, s74, 40960
    s_add_u32 s74, s63, 1
    s_and_b32 s74, s74, 3
    s_mul_i32 s67, s74, 4096
    s_mul_i32 s71, s74, 40960
    s_add_u32 s74, s63, 2
    s_and_b32 s74, s74, 3
    s_mul_i32 s68, s74, 4096
    s_mul_i32 s72, s74, 40960
    s_add_u32 s74, s63, 3
    s_and_b32 s74, s74, 3
    s_mul_i32 s69, s74, 4096
    s_mul_i32 s73, s74, 40960
    s_mov_b32 s31, 0
L1lx:
    s_cmp_lt_u32 s26, 3
    s_cbranch_scc1 L1lxgo
    s_sub_u32 s28, s26, 2
L1lxw:
    ds_read_b32 v12, v8
    s_cmp_eq_u32 s31, s26
    s_cbranch_scc1 L1lxnp
    s_getreg_b32 s64, hwreg(HW_REG_IB_STS)
    s_and_b32 s64, s64, 0x00c0000f
    s_cbranch_scc1 L1lxnp
    s_waitcnt vmcnt(0)
    v_mov_b32 v10, s26
    v_mov_b32 v11, s26
    s_mov_b32 s31, s26
    ds_write_b64 v9, v[10:11]
L1lxnp:
    s_waitcnt lgkmcnt(0)
    v_cmp_gt_u32 vcc, s28, v12
    s_nop 0
    s_cmp_eq_u64 vcc, 0
    s_cbranch_scc1 L1lxgo
    s_add_u32 s93, s93, 1
    s_cmp_gt_u32 s93, 0x80000
    s_cbranch_scc1 L1lxgo
    s_sleep 2
    s_branch L1lxw
L1lxgo:
    s_lshl_b32 s24, s26, 7
    s_add_u32 m0, s27, s66
    s_add_u32 s25, s24, s70
    buffer_load_dwordx4 v4, s[8:11], s25 offen offset:0 lds
    buffer_load_dwordx4 v5, s[8:11], s25 offen offset:1024 lds
    buffer_load_dwordx4 v6, s[8:11], s25 offen offset:2048 lds
    buffer_load_dwordx4 v7, s[8:11], s25 offen offset:3072 lds
    s_cmp_eq_u32 s31, s26
    s_cbranch_scc1 L1xe0
    s_getreg_b32 s64, hwreg(HW_REG_IB_STS)
    s_and_b32 s65, s64, 0x00c00000
    s_cbranch_scc1 L1xe0
    s_and_b32 s64, s64, 15
    s_cmp_gt_u32 s64, 4
    s_cbranch_scc1 L1xe0
    s_waitcnt vmcnt(4)
    v_mov_b32 v10, s26
    v_mov_b32 v11, s26
    s_mov_b32 s31, s26
    ds_write_b64 v9, v[10:11]
L1xe0:
    s_add_u32 m0, s27, s67
    s_add_u32 s25, s24, s71
    s_nop 0
    buffer_load_dwordx4 v4, s[8:11], s25 offen offset:0 lds
    buffer_load_dwordx4 v5, s[8:11], s25 offen offset:1024 lds
    buffer_load_dwordx4 v6, s[8:11], s25 offen offset:2048 lds
    buffer_load_dwordx4 v7, s[8:11], s25 offen offset:3072 lds
    s_cmp_eq_u32 s31, s26
    s_cbranch_scc1 L1xe1
    s_getreg_b32 s64, hwreg(HW_REG_IB_STS)
    s_and_b32 s65, s64, 0x00c00000
    s_cbranch_scc1 L1xe1
    s_and_b32 s64, s64, 15
    s_cmp_gt_u32 s64, 8
    s_cbranch_scc1 L1xe1
    s_waitcnt vmcnt(8)
    v_mov_b32 v10, s26
    v_mov_b32 v11, s26
    s_mov_b32 s31, s26
    ds_write_b64 v9, v[10:11]
L1xe1:
    s_add_u32 m0, s27, s68
    s_add_u32 s25, s24, s72
    s_nop 0
    buffer_load_dwordx4 v4, s[8:11], s25 offen offset:0 lds
    buffer_load_dwordx4 v5, s[8:11], s25 offen offset:1024 lds
    buffer_load_dwordx4 v6, s[8:11], s25 offen offset:2048 lds
    buffer_load_dwordx4 v7, s[8:11], s25 offen offset:3072 lds
    s_cmp_eq_u32 s31, s26
    s_cbranch_scc1 L1xe2
    s_getreg_b32 s64, hwreg(HW_REG_IB_STS)
    s_and_b32 s65, s64, 0x00c00000
    s_cbranch_scc1 L1xe2
    s_and_b32 s64, s64, 15
    s_cmp_gt_u32 s64, 12
    s_cbranch_scc1 L1xe2
    s_waitcnt vmcnt(12)
    v_mov_b32 v10, s26
    v_mov_b32 v11, s26
    s_mov_b32 s31, s26
    ds_write_b64 v9, v[10:11]
L1xe2:
    s_add_u32 m0, s27, s69
    s_add_u32 s25, s24, s73
    s_nop 0
    buffer_load_dwordx4 v4, s[8:11], s25 offen offset:0 lds
    buffer_load_dwordx4 v5, s[8:11], s25 offen offset:1024 lds
    buffer_load_dwordx4 v6, s[8:11], s25 offen offset:2048 lds
    buffer_load_dwordx4 v7, s[8:11], s25 offen offset:3072 lds
    s_add_u32 s27, s27, 41088
    s_cmp_eq_u32 s27, s29
    s_cselect_b32 s27, 0, s27
    s_cmp_eq_u32 s31, s26
    s_cbranch_scc1 L1lxdn
    v_mov_b32 v10, s26
    v_mov_b32 v11, s26
    s_mov_b32 s31, s26
    s_waitcnt vmcnt(16)
    ds_write_b64 v9, v[10:11]
L1lxdn:
    s_add_u32 s26, s26, 1
    s_cmp_lt_u32 s26, 10
    s_cbranch_scc1 L1lx
    s_branch L1lddone
L1ldW:
    v_add_u32 v20, 0, v0
    v_mul_u32_u24 v21, 43691, v20
    v_lshrrev_b32 v21, 19, v21
    v_mul_u32_u24 v22, 12, v21
    v_sub_u32 v22, v20, v22
    v_mul_u32_u24 v21, 3072, v21
    v_lshl_add_u32 v1, v22, 4, v21
    v_add_u32 v20, 64, v0
    v_mul_u32_u24 v21, 43691, v20
    v_lshrrev_b32 v21, 19, v21
    v_mul_u32_u24 v22, 12, v21
    v_sub_u32 v22, v20, v22
    v_mul_u32_u24 v21, 3072, v21
    v_lshl_add_u32 v2, v22, 4, v21
    v_subrev_u32 v2, 1024, v2
    v_add_u32 v20, 128, v0
    v_mul_u32_u24 v21, 43691, v20
    v_lshrrev_b32 v21, 19, v21
    v_mul_u32_u24 v22, 12, v21
    v_sub_u32_e64 v22, v20, v22
    v_mul_u32_u24 v21, 3072, v21
    v_lshl_add_u32 v3, v22, 4, v21
    v_subrev_u32 v3, 2048, v3
    v_mul_u32_u24 v20, 43691, v0
    v_lshrrev_b32 v20, 19, v20
    v_mul_u32_u24 v21, 12, v20
    v_sub_u32 v21, v0, v21
    v_mul_u32_u24 v20, 196608, v20
    v_lshl_add_u32 v23, v21, 6, v20
    s_lshr_b32 s64, s2, 3
    s_lshl_b32 s65, s60, 5
    s_add_u32 s64, s64, s65
    s_mul_i32 s64, s64, 3072
    s_mul_i32 s65, s61, 768
    s_add_u32 s64, s64, s65
    s_nop 0
    s_mul_i32 s24, s5, 192
    s_mul_i32 s30, s3, 12320
    s_add_u32 s30, s30, 4064
    s_mov_b32 s27, s30
    s_add_u32 s29, s30, 123264
    s_cmp_eq_u32 s3, 2
    s_waitcnt lgkmcnt(0)
    s_cselect_b32 s12, s50, s48
    s_cselect_b32 s13, s51, s49
    s_mov_b32 s14, 1966080
    s_mov_b32 s15, 0x20000
    s_mov_b32 s75, s64
    s_add_u32 s75, s75, 196608
    s_mov_b32 exec_lo, 4294967295
    s_mov_b32 exec_hi, 15
    buffer_load_dword v24, v23, s[12:15], s75 offen sc1
    s_mov_b64 exec, -1
    s_add_u32 s74, s62, 0
    s_and_b32 s74, s74, 3
    s_mul_i32 s66, s74, 3072
    s_mul_i32 s70, s74, 49152
    s_add_u32 s74, s62, 1
    s_and_b32 s74, s74, 3
    s_mul_i32 s67, s74, 3072
    s_mul_i32 s71, s74, 49152
    s_add_u32 s74, s62, 2
    s_and_b32 s74, s74, 3
    s_mul_i32 s68, s74, 3072
    s_mul_i32 s72, s74, 49152
    s_add_u32 s74, s62, 3
    s_and_b32 s74, s74, 3
    s_mul_i32 s69, s74, 3072
    s_mul_i32 s73, s74, 49152
    s_mov_b32 s31, 0
L1lw:
    s_cmp_lt_u32 s26, 3
    s_cbranch_scc1 L1lwgo
    s_sub_u32 s28, s26, 2
L1lww:
    ds_read_b32 v12, v8
    s_cmp_eq_u32 s31, s26
    s_cbranch_scc1 L1lwnp
    s_getreg_b32 s64, hwreg(HW_REG_IB_STS)
    s_and_b32 s64, s64, 0x00c0000f
    s_cbranch_scc1 L1lwnp
    s_waitcnt vmcnt(0)
    v_mov_b32 v10, s26
    v_mov_b32 v11, s26
    s_mov_b32 s31, s26
    ds_write_b64 v9, v[10:11]
L1lwnp:
    s_waitcnt lgkmcnt(0)
    v_cmp_gt_u32 vcc, s28, v12
    s_nop 0
    s_cmp_eq_u64 vcc, 0
    s_cbranch_scc1 L1lwgo
    s_add_u32 s93, s93, 1
    s_cmp_gt_u32 s93, 0x80000
    s_cbranch_scc1 L1lwgo
    s_sleep 2
    s_branch L1lww
L1lwgo:
    s_add_u32 m0, s27, s66
    s_add_u32 s25, s24, s70
    buffer_load_dwordx4 v1, s[12:15], s25 offen offset:0 lds
    buffer_load_dwordx4 v2, s[12:15], s25 offen offset:1024 lds
    buffer_load_dwordx4 v3, s[12:15], s25 offen offset:2048 lds
    s_cmp_eq_u32 s31, s26
    s_cbranch_scc1 L1we0
    s_getreg_b32 s64, hwreg(HW_REG_IB_STS)
    s_and_b32 s65, s64, 0x00c00000
    s_cbranch_scc1 L1we0
    s_and_b32 s64, s64, 15
    s_cmp_gt_u32 s64, 3
    s_cbranch_scc1 L1we0
    s_waitcnt vmcnt(3)
    v_mov_b32 v10, s26
    v_mov_b32 v11, s26
    s_mov_b32 s31, s26
    ds_write_b64 v9, v[10:11]
L1we0:
    s_add_u32 m0, s27, s67
    s_add_u32 s25, s24, s71
    s_nop 0
    buffer_load_dwordx4 v1, s[12:15], s25 offen offset:0 lds
    buffer_load_dwordx4 v2, s[12:15], s25 offen offset:1024 lds
    buffer_load_dwordx4 v3, s[12:15], s25 offen offset:2048 lds
    s_cmp_eq_u32 s31, s26
    s_cbranch_scc1 L1we1
    s_getreg_b32 s64, hwreg(HW_REG_IB_STS)
    s_and_b32 s65, s64, 0x00c00000
    s_cbranch_scc1 L1we1
    s_and_b32 s64, s64, 15
    s_cmp_gt_u32 s64, 6
    s_cbranch_scc1 L1we1
    s_waitcnt vmcnt(6)
    v_mov_b32 v10, s26
    v_mov_b32 v11, s26
    s_mov_b32 s31, s26
    ds_write_b64 v9, v[10:11]
L1we1:
    s_add_u32 m0, s27, s68
    s_add_u32 s25, s24, s72
    s_nop 0
    buffer_load_dwordx4 v1, s[12:15], s25 offen offset:0 lds
    buffer_load_dwordx4 v2, s[12:15], s25 offen offset:1024 lds
    buffer_load_dwordx4 v3, s[12:15], s25 offen offset:2048 lds
    s_cmp_eq_u32 s31, s26
    s_cbranch_scc1 L1we2
    s_getreg_b32 s64, hwreg(HW_REG_IB_STS)
    s_and_b32 s65, s64, 0x00c00000
    s_cbranch_scc1 L1we2
    s_and_b32 s64, s64, 15
    s_cmp_gt_u32 s64, 9
    s_cbranch_scc1 L1we2
    s_waitcnt vmcnt(9)
    v_mov_b32 v10, s26
    v_mov_b32 v11, s26
    s_mov_b32 s31, s26
    ds_write_b64 v9, v[10:11]
L1we2:
    s_add_u32 m0, s27, s69
    s_add_u32 s25, s24, s73
    s_nop 0
    buffer_load_dwordx4 v1, s[12:15], s25 offen offset:0 lds
    buffer_load_dwordx4 v2, s[12:15], s25 offen offset:1024 lds
    buffer_load_dwordx4 v3, s[12:15], s25 offen offset:2048 lds
    s_add_u32 s24, s24, 196608
    s_add_u32 s27, s27, 41088
    s_cmp_eq_u32 s27, s29
    s_cselect_b32 s27, s30, s27
    s_cmp_eq_u32 s31, s26
    s_cbranch_scc1 L1lwdn
    v_mov_b32 v10, s26
    v_mov_b32 v11, s26
    s_mov_b32 s31, s26
    s_waitcnt vmcnt(12)
    ds_write_b64 v9, v[10:11]
L1lwdn:
    s_add_u32 s26, s26, 1
    s_cmp_lt_u32 s26, 10
    s_cbranch_scc1 L1lw
    s_branch L1lddone
L1lddone:
    v_mov_b32 v10, 10
    v_mov_b32 v11, 10
    s_waitcnt vmcnt(0)
    ds_write_b64 v9, v[10:11]
    s_mov_b32 s27, 41088
    s_mov_b32 s16, s58
    s_mov_b32 s17, s59
    s_mov_b32 s18, 268435456
    s_mov_b32 s19, 0x20000
    s_cmp_eq_u32 s3, 1
    s_cbranch_scc1 L1rep
    s_cmp_eq_u32 s3, 0
    s_cbranch_scc0 L1nos3
    v_mov_b32 v20, -1
    v_mov_b32 v21, -1
    v_mov_b32 v22, -1
    v_mov_b32 v23, -1
    v_lshlrev_b32 v12, 4, v0
    s_mul_i32 s76, s2, 10240
    s_add_u32 s76, s76, 20971520
    buffer_store_dwordx4 v[20:23], v12, s[16:19], s76 offen offset:0 sc1
    buffer_store_dwordx4 v[20:23], v12, s[16:19], s76 offen offset:1024 sc1
    buffer_store_dwordx4 v[20:23], v12, s[16:19], s76 offen offset:2048 sc1
    buffer_store_dwordx4 v[20:23], v12, s[16:19], s76 offen offset:3072 sc1
    s_add_u32 s76, s76, 4096
    buffer_store_dwordx4 v[20:23], v12, s[16:19], s76 offen offset:0 sc1
    buffer_store_dwordx4 v[20:23], v12, s[16:19], s76 offen offset:1024 sc1
    buffer_store_dwordx4 v[20:23], v12, s[16:19], s76 offen offset:2048 sc1
    buffer_store_dwordx4 v[20:23], v12, s[16:19], s76 offen offset:3072 sc1
    s_add_u32 s76, s76, 4096
    buffer_store_dwordx4 v[20:23], v12, s[16:19], s76 offen offset:0 sc1
    buffer_store_dwordx4 v[20:23], v12, s[16:19], s76 offen offset:1024 sc1
    s_branch L1ldend
L1nos3:
    s_lshl_b32 s69, s2, 7
    s_add_u32 s69, s69, 524288
    v_mov_b32 v40, 0
    v_mov_b32 v41, 0
    v_mov_b32 v42, 0
    v_mov_b32 v43, 0
    s_mov_b64 exec, 1
    buffer_store_dwordx4 v[40:43], v40, s[16:19], s69 offen
    s_mov_b64 exec, -1
    s_getpc_b64 s[20:21]
L1pc2:
    s_lshr_b32 s64, s2, 3
    s_lshl_b32 s64, s64, 10
    s_min_u32 s64, s64, L2end-k2_kernel-1024
    s_add_u32 s20, s20, k2_kernel-L1pc2
    s_addc_u32 s21, s21, 0
    v_lshl_add_u32 v10, v0, 4, s64
    global_load_dwordx4 v[44:47], v10, s[20:21]
    s_branch L1ldend
L1rep:
    s_cmp_ge_u32 s2, 192
    s_cbranch_scc1 L1ldend
    s_mov_b32 s12, s52
    s_mov_b32 s13, s53
    s_mov_b32 s14, 1966080
    s_mov_b32 s15, 0x20000
    s_lshr_b32 s24, s2, 1
    s_mul_i32 s24, s24, 20480
    s_mul_i32 s25, s60, 640
    s_add_u32 s24, s24, s25
    v_add_u32 v20, 0, v0
    v_mul_u32_u24 v21, 52429, v20
    v_lshrrev_b32 v21, 21, v21
    v_mul_u32_u24 v22, 40, v21
    v_sub_u32 v22, v20, v22
    v_mul_u32_u24 v21, 1280, v21
    v_lshl_add_u32 v30, v22, 4, v21
    v_add_u32 v20, 64, v0
    v_mul_u32_u24 v21, 52429, v20
    v_lshrrev_b32 v21, 21, v21
    v_mul_u32_u24 v22, 40, v21
    v_sub_u32 v22, v20, v22
    v_mul_u32_u24 v21, 1280, v21
    v_lshl_add_u32 v31, v22, 4, v21
    v_add_u32 v20, 128, v0
    v_mul_u32_u24 v21, 52429, v20
    v_lshrrev_b32 v21, 21, v21
    v_mul_u32_u24 v22, 40, v21
    v_sub_u32_e64 v22, v20, v22
    v_mul_u32_u24 v21, 1280, v21
    v_lshl_add_u32 v32, v22, 4, v21
    v_add_u32 v20, 192, v0
    v_mul_u32_u24 v21, 52429, v20
    v_lshrrev_b32 v21, 21, v21
    v_mul_u32_u24 v22, 40, v21
    v_sub_u32_e64 v22, v20, v22
    v_mul_u32_u24 v21, 1280, v21
    v_lshl_add_u32 v33, v22, 4, v21
    v_add_u32 v20, 256, v0
    v_mul_u32_u24 v21, 52429, v20
    v_lshrrev_b32 v21, 21, v21
    v_mul_u32_u24 v22, 40, v21
    v_sub_u32_e64 v22, v20, v22
    v_mul_u32_u24 v21, 1280, v21
    v_lshl_add_u32 v34, v22, 4, v21
    v_bfe_u32 v40, v0, 4, 1
    v_bfe_u32 v41, v0, 2, 2
    v_lshl_add_u32 v40, v40, 2, v41
    v_mul_u32_u24 v40, 640, v40
    v_and_b32_e64 v41, 3, v0
    v_lshl_add_u32 v42, v41, 4, v40
    v_lshl_add_u32 v43, v41, 3, v40
    v_cmp_lt_u32 s[72:73], 31, v0
    v_and_b32 v44, 31, v0
    v_lshlrev_b32 v44, 4, v44
    v_lshrrev_b32 v45, 5, v0
    v_lshl_add_u32 v44, v45, 10, v44
    s_lshr_b32 s69, s2, 2
    s_mul_i32 s69, s69, 40
    s_mul_i32 s70, s60, 20
    s_add_u32 s69, s69, s70
    s_lshl_b32 s69, s69, 10
    s_bfe_u32 s70, s2, 0x10001
    s_lshl_b32 s70, s70, 9
    s_add_u32 s69, s69, s70
    s_add_u32 s69, s69, 10485760
    v_add_u32 v46, 0, v42
    v_add_u32 v47, 8, v42
    v_cndmask_b32 v50, v46, v47, s[72:73]
    v_add_u32_e64 v46, 64, v42
    v_add_u32 v47, 72, v42
    v_cndmask_b32 v51, v46, v47, s[72:73]
    v_add_u32 v46, 128, v43
    v_add_u32 v47, 160, v42
    v_cndmask_b32 v52, v46, v47, s[72:73]
    v_add_u32 v46, 168, v42
    v_add_u32 v47, 224, v42
    v_cndmask_b32 v53, v46, v47, s[72:73]
    v_add_u32 v46, 232, v42
    v_add_u32 v47, 288, v43
    v_cndmask_b32 v54, v46, v47, s[72:73]
    v_add_u32 v46, 320, v42
    v_add_u32 v47, 328, v42
    v_cndmask_b32 v55, v46, v47, s[72:73]
    v_add_u32 v46, 384, v42
    v_add_u32 v47, 392, v42
    v_cndmask_b32 v56, v46, v47, s[72:73]
    v_add_u32 v46, 448, v43
    v_add_u32 v47, 480, v42
    v_cndmask_b32 v57, v46, v47, s[72:73]
    v_add_u32 v46, 488, v42
    v_add_u32 v47, 544, v42
    v_cndmask_b32 v58, v46, v47, s[72:73]
    v_add_u32 v46, 552, v42
    v_add_u32 v47, 608, v43
    v_cndmask_b32 v59, v46, v47, s[72:73]
L1rw:
    ds_read_b32 v12, v8 offset:0
    s_waitcnt lgkmcnt(0)
    v_cmp_gt_u32 vcc, 8, v12
    s_nop 0
    s_cmp_eq_u64 vcc, 0
    s_cbranch_scc1 L1rwk
    s_add_u32 s93, s93, 1
    s_cmp_gt_u32 s93, 0x80000
    s_cbranch_scc1 L1rwk
    s_sleep 1
    s_branch L1rw
L1rwk:
    s_add_u32 m0, s27, 0
    s_nop 0
    buffer_load_dwordx4 v30, s[12:15], s24 offen lds
    s_add_u32 m0, s27, 1024
    s_nop 0
    buffer_load_dwordx4 v31, s[12:15], s24 offen lds
    s_add_u32 m0, s27, 2048
    s_nop 0
    buffer_load_dwordx4 v32, s[12:15], s24 offen lds
    s_add_u32 m0, s27, 3072
    s_nop 0
    buffer_load_dwordx4 v33, s[12:15], s24 offen lds
    s_add_u32 m0, s27, 4096
    s_nop 0
    s_nop 0
    buffer_load_dwordx4 v34, s[12:15], s24 offen lds
    s_add_u32 m0, s27, 5120
    s_add_u32 s24, s24, 10240
    buffer_load_dwordx4 v30, s[12:15], s24 offen lds
    s_add_u32 m0, s27, 6144
    s_nop 0
    buffer_load_dwordx4 v31, s[12:15], s24 offen lds
    s_add_u32 m0, s27, 7168
    s_nop 0
    buffer_load_dwordx4 v32, s[12:15], s24 offen lds
    s_add_u32 m0, s27, 8192
    s_nop 0
    buffer_load_dwordx4 v33, s[12:15], s24 offen lds
    s_add_u32 m0, s27, 9216
    s_nop 0
    buffer_load_dwordx4 v34, s[12:15], s24 offen lds
    s_waitcnt vmcnt(0)
    s_nop 0
    ds_read_b64_tr_b16 v[64:65], v50 offset:41088
    ds_read_b64_tr_b16 v[66:67], v50 offset:46208
    ds_read_b64_tr_b16 v[68:69], v51 offset:41088
    ds_read_b64_tr_b16 v[70:71], v51 offset:46208
    ds_read_b64_tr_b16 v[72:73], v52 offset:41088
    ds_read_b64_tr_b16 v[74:75], v52 offset:46208
    ds_read_b64_tr_b16 v[76:77], v53 offset:41088
    ds_read_b64_tr_b16 v[78:79], v53 offset:46208
    ds_read_b64_tr_b16 v[80:81], v54 offset:41088
    ds_read_b64_tr_b16 v[82:83], v54 offset:46208
    ds_read_b64_tr_b16 v[84:85], v55 offset:41088
    ds_read_b64_tr_b16 v[86:87], v55 offset:46208
    ds_read_b64_tr_b16 v[88:89], v56 offset:41088
    ds_read_b64_tr_b16 v[90:91], v56 offset:46208
    ds_read_b64_tr_b16 v[92:93], v57 offset:41088
    ds_read_b64_tr_b16 v[94:95], v57 offset:46208
    ds_read_b64_tr_b16 v[96:97], v58 offset:41088
    ds_read_b64_tr_b16 v[98:99], v58 offset:46208
    ds_read_b64_tr_b16 v[100:101], v59 offset:41088
    ds_read_b64_tr_b16 v[102:103], v59 offset:46208
    s_waitcnt lgkmcnt(15)
    buffer_store_dwordx4 v[64:67], v44, s[16:19], s69 offen offset:0 sc1
    s_waitcnt lgkmcnt(15)
    buffer_store_dwordx4 v[68:71], v44, s[16:19], s69 offen offset:2048 sc1
    s_waitcnt lgkmcnt(14)
    s_add_u32 s69, s69, 4096
    buffer_store_dwordx4 v[72:75], v44, s[16:19], s69 offen offset:0 sc1
    s_waitcnt lgkmcnt(12)
    buffer_store_dwordx4 v[76:79], v44, s[16:19], s69 offen offset:2048 sc1
    s_waitcnt lgkmcnt(10)
    s_add_u32 s69, s69, 4096
    buffer_store_dwordx4 v[80:83], v44, s[16:19], s69 offen offset:0 sc1
    s_waitcnt lgkmcnt(8)
    buffer_store_dwordx4 v[84:87], v44, s[16:19], s69 offen offset:2048 sc1
    s_waitcnt lgkmcnt(6)
    s_add_u32 s69, s69, 4096
    buffer_store_dwordx4 v[88:91], v44, s[16:19], s69 offen offset:0 sc1
    s_waitcnt lgkmcnt(4)
    buffer_store_dwordx4 v[92:95], v44, s[16:19], s69 offen offset:2048 sc1
    s_waitcnt lgkmcnt(2)
    s_add_u32 s69, s69, 4096
    buffer_store_dwordx4 v[96:99], v44, s[16:19], s69 offen offset:0 sc1
    s_waitcnt lgkmcnt(0)
    buffer_store_dwordx4 v[100:103], v44, s[16:19], s69 offen offset:2048 sc1
L1ldend:
    s_endpgm
L1notload:
    s_cmp_ge_u32 s3, 9
    s_cbranch_scc1 L1kg
    s_cmp_eq_u32 s3, 3
    s_cbranch_scc1 L1misc
    s_cmp_eq_u32 s3, 8
    s_cbranch_scc1 L1misc
    s_sub_u32 s3, s3, 4
    s_and_b32 s66, s3, 1
    s_lshr_b32 s67, s3, 1
    v_lshrrev_b32_e64 v10, 5, v0
    v_bfe_u32 v11, v0, 2, 2
    v_lshl_add_u32 v10, v10, 3, v11
    v_mul_u32_u24 v10, 192, v10
    v_bfe_u32 v11, v0, 4, 1
    v_mul_u32_u24 v11, 12320, v11
    v_add_u32 v10, v10, v11
    v_and_b32 v11, 3, v0
    v_lshl_add_u32 v10, v11, 3, v10
    s_mul_i32 s64, s67, 96
    s_add_u32 s64, s64, 16384
    s_mul_i32 s65, s66, 6144
    s_add_u32 s68, s64, s65
    s_sub_u32 s69, s64, s65
    s_add_u32 s69, s69, 6144
    v_add_u32 v1, s68, v10
    v_add_u32 v15, s69, v10
    v_and_b32 v10, 31, v0
    v_lshrrev_b32 v11, 5, v0
    v_bfe_u32 v12, v10, 1, 3
    v_xor_b32 v12, v12, v11
    v_lshlrev_b32 v12, 4, v12
    v_lshl_add_u32 v2, v10, 7, v12
    s_lshl_b32 s64, s66, 13
    s_lshl_b32 s65, s66, 6
    v_add_u32 v2, s64, v2
    v_xor_b32 v2, s65, v2
    v_xor_b32 v3, 32, v2
    v_xor_b32 v7, 64, v2
    v_xor_b32 v8, 96, v2
    v_and_b32 v13, 15, v10
    v_bfe_u32 v14, v0, 4, 1
    v_sub_u32 v14, v13, v14
    v_mov_b32 v9, 0x3f803f80
    v_cmp_eq_u32 vcc, 0, v14
    v_cmp_eq_u32 s[72:73], 4, v14
    v_cmp_eq_u32 s[74:75], 8, v14
    v_cndmask_b32 v56, 0, v9, vcc
    v_cndmask_b32 v60, 0, v9, s[72:73]
    v_cndmask_b32 v64, 0, v9, s[74:75]
    v_mov_b32 v57, v56
    v_mov_b32 v58, v56
    v_mov_b32 v59, v56
    v_mov_b32 v61, v60
    v_mov_b32 v62, v60
    v_mov_b32 v63, v60
    v_mov_b32 v65, v64
    v_mov_b32 v66, v64
    v_mov_b32 v67, v64
    s_lshl_b32 s64, s3, 8
    s_add_u32 s64, s64, 149312
    v_lshl_add_u32 v13, v0, 2, s64
    s_lshl_b32 s72, s66, 9
    s_nop 0
    s_add_u32 s72, s72, 146752
    s_mul_i32 s73, s67, 1536
    s_add_u32 s73, s73, 143680
    s_lshl_b32 s71, s66, 8
    s_add_u32 s70, s73, s71
    s_xor_b32 s74, s3, 1
    s_lshl_b32 s74, s74, 8
    s_add_u32 s74, s74, 149312
    s_add_u32 s75, s71, 151616
    s_lshl_b32 s64, s4, 3
    s_lshl_b32 s65, s66, 2
    s_add_u32 s64, s64, s65
    s_mul_i32 s64, s64, 96
    s_mul_i32 s65, s5, 6
    s_add_u32 s64, s64, s65
    s_mul_i32 s65, s67, 3
    s_add_u32 s64, s64, s65
    s_lshl_b32 s64, s64, 9
    s_add_u32 s64, s64, 12582912
    s_add_u32 s65, s64, 98304
    s_mov_b32 s68, 0x07060302
    s_mov_b32 s27, 41088
    s_mov_b32 s28, 0
    s_waitcnt lgkmcnt(0)
    s_mov_b32 s16, s58
    s_mov_b32 s17, s59
    s_mov_b32 s18, 268435456
    s_mov_b32 s19, 0x20000
    s_waitcnt vmcnt(0)
L1g0:
    ds_read_b32 v12, v13 offset:3072
    s_waitcnt lgkmcnt(0)
    v_cmp_gt_u32 vcc, 1, v12
    s_nop 0
    s_cmp_eq_u64 vcc, 0
    s_cbranch_scc1 L1g0k
    s_add_u32 s93, s93, 1
    s_cmp_gt_u32 s93, 0x80000
    s_cbranch_scc1 L1g0k
    s_sleep 1
    s_branch L1g0
L1g0k:
    s_setprio 1
    s_mov_b32 s92, 0
    ds_read_b128 v[28:31], v2
    ds_read_b64_tr_b16 v[16:17], v1 offset:0
    ds_read_b64_tr_b16 v[18:19], v1 offset:768
    ds_read_b128 v[32:35], v2 offset:4096
    ds_read_b64_tr_b16 v[20:21], v1 offset:32
    ds_read_b64_tr_b16 v[22:23], v1 offset:800
    ds_read_b64_tr_b16 v[24:25], v1 offset:64
    ds_read_b64_tr_b16 v[26:27], v1 offset:832
    s_waitcnt lgkmcnt(5)
    s_nop 0
    v_mfma_f32_32x32x16_bf16 v[72:87], v[16:19], v[28:31], 0
    ds_read_b128 v[48:51], v3
    ds_read_b64_tr_b16 v[36:37], v1 offset:3072
    ds_read_b64_tr_b16 v[38:39], v1 offset:3840
    ds_read_b128 v[52:55], v3 offset:4096
    s_waitcnt lgkmcnt(8)
    s_nop 0
    v_mfma_f32_32x32x16_bf16 v[120:135], v[16:19], v[32:35], 0
    ds_read_b64_tr_b16 v[40:41], v1 offset:3104
    ds_read_b64_tr_b16 v[42:43], v1 offset:3872
    ds_read_b64_tr_b16 v[44:45], v1 offset:3136
    ds_read_b64_tr_b16 v[46:47], v1 offset:3904
    v_mfma_f32_16x16x32_bf16 v[68:71], v[56:59], v[16:19], 0
    s_waitcnt lgkmcnt(10)
    s_nop 0
    v_mfma_f32_32x32x16_bf16 v[88:103], v[20:23], v[28:31], 0
    v_mfma_f32_32x32x16_bf16 v[136:151], v[20:23], v[32:35], 0
    v_mfma_f32_16x16x32_bf16 v[68:71], v[60:63], v[20:23], v[68:71]
    s_waitcnt lgkmcnt(8)
    s_nop 0
    v_mfma_f32_32x32x16_bf16 v[104:119], v[24:27], v[28:31], 0
    v_mfma_f32_32x32x16_bf16 v[152:167], v[24:27], v[32:35], 0
    v_mfma_f32_16x16x32_bf16 v[68:71], v[64:67], v[24:27], v[68:71]
    s_waitcnt lgkmcnt(5)
    s_nop 0
    v_mfma_f32_32x32x16_bf16 v[72:87], v[36:39], v[48:51], v[72:87]
    ds_read_b128 v[28:31], v7
    ds_read_b64_tr_b16 v[16:17], v15 offset:0
    ds_read_b64_tr_b16 v[18:19], v15 offset:768
    ds_read_b128 v[32:35], v7 offset:4096
    s_waitcnt lgkmcnt(8)
    s_nop 0
    v_mfma_f32_32x32x16_bf16 v[120:135], v[36:39], v[52:55], v[120:135]
    ds_read_b64_tr_b16 v[20:21], v15 offset:32
    ds_read_b64_tr_b16 v[22:23], v15 offset:800
    ds_read_b64_tr_b16 v[24:25], v15 offset:64
    ds_read_b64_tr_b16 v[26:27], v15 offset:832
    v_mfma_f32_16x16x32_bf16 v[68:71], v[56:59], v[36:39], v[68:71]
    s_waitcnt lgkmcnt(10)
    s_nop 0
    v_mfma_f32_32x32x16_bf16 v[88:103], v[40:43], v[48:51], v[88:103]
    v_mfma_f32_32x32x16_bf16 v[136:151], v[40:43], v[52:55], v[136:151]
    v_mfma_f32_16x16x32_bf16 v[68:71], v[60:63], v[40:43], v[68:71]
    s_waitcnt lgkmcnt(8)
    s_nop 0
    v_mfma_f32_32x32x16_bf16 v[104:119], v[44:47], v[48:51], v[104:119]
    v_mfma_f32_32x32x16_bf16 v[152:167], v[44:47], v[52:55], v[152:167]
    ds_read_b32 v12, v13 offset:3072
    v_mfma_f32_16x16x32_bf16 v[68:71], v[64:67], v[44:47], v[68:71]
    s_waitcnt lgkmcnt(6)
    s_nop 0
    v_mfma_f32_32x32x16_bf16 v[72:87], v[16:19], v[28:31], v[72:87]
    ds_read_b128 v[48:51], v8
    ds_read_b64_tr_b16 v[36:37], v15 offset:3072
    ds_read_b64_tr_b16 v[38:39], v15 offset:3840
    ds_read_b128 v[52:55], v8 offset:4096
    s_waitcnt lgkmcnt(9)
    s_nop 0
    v_mfma_f32_32x32x16_bf16 v[120:135], v[16:19], v[32:35], v[120:135]
    ds_read_b64_tr_b16 v[40:41], v15 offset:3104
    ds_read_b64_tr_b16 v[42:43], v15 offset:3872
    ds_read_b64_tr_b16 v[44:45], v15 offset:3136
    ds_read_b64_tr_b16 v[46:47], v15 offset:3904
    s_waitcnt lgkmcnt(11)
    v_mfma_f32_32x32x16_bf16 v[88:103], v[20:23], v[28:31], v[88:103]
    v_add_u32 v4, s27, v1
    v_add_u32 v11, s27, v15
    v_add_u32 v5, s27, v2
    v_mfma_f32_32x32x16_bf16 v[136:151], v[20:23], v[32:35], v[136:151]
    v_add_u32 v6, s27, v3
    v_add_u32 v9, s27, v7
    v_add_u32 v10, s27, v8
    s_waitcnt lgkmcnt(9)
    v_mfma_f32_32x32x16_bf16 v[104:119], v[24:27], v[28:31], v[104:119]
    s_add_u32 s27, s27, 41088
    s_cmp_eq_u32 s27, 123264
    s_cselect_b32 s27, 0, s27
    v_mfma_f32_32x32x16_bf16 v[152:167], v[24:27], v[32:35], v[152:167]
    s_add_u32 s28, s28, 1
    s_cmp_lt_u32 s28, 9
L1g1loop:
    s_waitcnt lgkmcnt(5)
    v_mfma_f32_32x32x16_bf16 v[72:87], v[36:39], v[48:51], v[72:87]
    v_cmp_ge_u32 vcc, s28, v12
    v_mov_b32 v14, s28
    s_cmp_eq_u64 vcc, 0
    s_cbranch_scc0 L1slowmid
L1backmid:
    ds_read_b128 v[28:31], v5
    ds_read_b64_tr_b16 v[16:17], v4 offset:0
    s_waitcnt lgkmcnt(6)
    s_nop 0
    v_mfma_f32_32x32x16_bf16 v[120:135], v[36:39], v[52:55], v[120:135]
    ds_read_b64_tr_b16 v[18:19], v4 offset:768
    ds_read_b128 v[32:35], v5 offset:4096
    ds_read_b64_tr_b16 v[20:21], v4 offset:32
    ds_read_b64_tr_b16 v[22:23], v4 offset:800
    s_waitcnt lgkmcnt(8)
    s_nop 0
    v_mfma_f32_32x32x16_bf16 v[88:103], v[40:43], v[48:51], v[88:103]
    ds_read_b64_tr_b16 v[24:25], v4 offset:64
    ds_read_b64_tr_b16 v[26:27], v4 offset:832
    v_mfma_f32_32x32x16_bf16 v[136:151], v[40:43], v[52:55], v[136:151]
    s_waitcnt lgkmcnt(8)
    s_nop 0
    v_mfma_f32_32x32x16_bf16 v[104:119], v[44:47], v[48:51], v[104:119]
    ds_write_b32 v13, v14
    v_mfma_f32_32x32x16_bf16 v[152:167], v[44:47], v[52:55], v[152:167]
    s_waitcnt lgkmcnt(6)
    s_nop 0
    v_mfma_f32_32x32x16_bf16 v[72:87], v[16:19], v[28:31], v[72:87]
    ds_read_b128 v[48:51], v6
    ds_read_b64_tr_b16 v[36:37], v4 offset:3072
    ds_read_b64_tr_b16 v[38:39], v4 offset:3840
    ds_read_b128 v[52:55], v6 offset:4096
    s_waitcnt lgkmcnt(9)
    s_nop 0
    v_mfma_f32_32x32x16_bf16 v[120:135], v[16:19], v[32:35], v[120:135]
    ds_read_b64_tr_b16 v[40:41], v4 offset:3104
    ds_read_b64_tr_b16 v[42:43], v4 offset:3872
    ds_read_b64_tr_b16 v[44:45], v4 offset:3136
    ds_read_b64_tr_b16 v[46:47], v4 offset:3904
    v_mfma_f32_16x16x32_bf16 v[68:71], v[56:59], v[16:19], v[68:71]
    s_waitcnt lgkmcnt(11)
    s_nop 0
    v_mfma_f32_32x32x16_bf16 v[88:103], v[20:23], v[28:31], v[88:103]
    v_mfma_f32_32x32x16_bf16 v[136:151], v[20:23], v[32:35], v[136:151]
    v_mfma_f32_16x16x32_bf16 v[68:71], v[60:63], v[20:23], v[68:71]
    s_waitcnt lgkmcnt(9)
    s_nop 0
    v_mfma_f32_32x32x16_bf16 v[104:119], v[24:27], v[28:31], v[104:119]
    v_mfma_f32_32x32x16_bf16 v[152:167], v[24:27], v[32:35], v[152:167]
    v_mfma_f32_16x16x32_bf16 v[68:71], v[64:67], v[24:27], v[68:71]
    s_waitcnt lgkmcnt(5)
    s_nop 0
    v_mfma_f32_32x32x16_bf16 v[72:87], v[36:39], v[48:51], v[72:87]
    ds_read_b128 v[28:31], v9
    ds_read_b64_tr_b16 v[16:17], v11 offset:0
    ds_read_b64_tr_b16 v[18:19], v11 offset:768
    ds_read_b128 v[32:35], v9 offset:4096
    s_waitcnt lgkmcnt(8)
    s_nop 0
    v_mfma_f32_32x32x16_bf16 v[120:135], v[36:39], v[52:55], v[120:135]
    ds_read_b64_tr_b16 v[20:21], v11 offset:32
    ds_read_b64_tr_b16 v[22:23], v11 offset:800
    ds_read_b64_tr_b16 v[24:25], v11 offset:64
    ds_read_b64_tr_b16 v[26:27], v11 offset:832
    v_mfma_f32_16x16x32_bf16 v[68:71], v[56:59], v[36:39], v[68:71]
    s_waitcnt lgkmcnt(10)
    s_nop 0
    v_mfma_f32_32x32x16_bf16 v[88:103], v[40:43], v[48:51], v[88:103]
    v_mfma_f32_32x32x16_bf16 v[136:151], v[40:43], v[52:55], v[136:151]
    v_mfma_f32_16x16x32_bf16 v[68:71], v[60:63], v[40:43], v[68:71]
    s_waitcnt lgkmcnt(8)
    s_nop 0
    v_mfma_f32_32x32x16_bf16 v[104:119], v[44:47], v[48:51], v[104:119]
    v_mfma_f32_32x32x16_bf16 v[152:167], v[44:47], v[52:55], v[152:167]
    ds_read_b32 v12, v13 offset:3072
    v_mfma_f32_16x16x32_bf16 v[68:71], v[64:67], v[44:47], v[68:71]
    s_waitcnt lgkmcnt(6)
    s_nop 0
    v_mfma_f32_32x32x16_bf16 v[72:87], v[16:19], v[28:31], v[72:87]
    ds_read_b128 v[48:51], v10
    ds_read_b64_tr_b16 v[36:37], v11 offset:3072
    ds_read_b64_tr_b16 v[38:39], v11 offset:3840
    ds_read_b128 v[52:55], v10 offset:4096
    s_waitcnt lgkmcnt(9)
    s_nop 0
    v_mfma_f32_32x32x16_bf16 v[120:135], v[16:19], v[32:35], v[120:135]
    ds_read_b64_tr_b16 v[40:41], v11 offset:3104
    ds_read_b64_tr_b16 v[42:43], v11 offset:3872
    ds_read_b64_tr_b16 v[44:45], v11 offset:3136
    ds_read_b64_tr_b16 v[46:47], v11 offset:3904
    s_waitcnt lgkmcnt(11)
    v_mfma_f32_32x32x16_bf16 v[88:103], v[20:23], v[28:31], v[88:103]
    v_add_u32 v4, s27, v1
    v_add_u32 v11, s27, v15
    v_add_u32 v5, s27, v2
    v_mfma_f32_32x32x16_bf16 v[136:151], v[20:23], v[32:35], v[136:151]
    v_add_u32 v6, s27, v3
    v_add_u32 v9, s27, v7
    v_add_u32 v10, s27, v8
    s_waitcnt lgkmcnt(9)
    v_mfma_f32_32x32x16_bf16 v[104:119], v[24:27], v[28:31], v[104:119]
    s_add_u32 s27, s27, 41088
    s_cmp_eq_u32 s27, 123264
    s_cselect_b32 s27, 0, s27
    v_mfma_f32_32x32x16_bf16 v[152:167], v[24:27], v[32:35], v[152:167]
    s_add_u32 s28, s28, 1
    s_cmp_lt_u32 s28, 9
    s_cbranch_scc1 L1g1loop
    s_waitcnt lgkmcnt(5)
    v_mfma_f32_32x32x16_bf16 v[72:87], v[36:39], v[48:51], v[72:87]
    v_cmp_ge_u32 vcc, s28, v12
    v_mov_b32 v14, s28
    s_cmp_eq_u64 vcc, 0
    s_cbranch_scc0 L1slowlast
L1backlast:
    ds_read_b128 v[28:31], v5
    ds_read_b64_tr_b16 v[16:17], v4 offset:0
    s_waitcnt lgkmcnt(6)
    v_mfma_f32_32x32x16_bf16 v[120:135], v[36:39], v[52:55], v[120:135]
    ds_read_b64_tr_b16 v[18:19], v4 offset:768
    ds_read_b128 v[32:35], v5 offset:4096
    ds_read_b64_tr_b16 v[20:21], v4 offset:32
    ds_read_b64_tr_b16 v[22:23], v4 offset:800
    s_waitcnt lgkmcnt(8)
    s_nop 0
    v_mfma_f32_32x32x16_bf16 v[88:103], v[40:43], v[48:51], v[88:103]
    ds_read_b64_tr_b16 v[24:25], v4 offset:64
    ds_read_b64_tr_b16 v[26:27], v4 offset:832
    v_mfma_f32_32x32x16_bf16 v[136:151], v[40:43], v[52:55], v[136:151]
    s_waitcnt lgkmcnt(8)
    s_nop 0
    v_mfma_f32_32x32x16_bf16 v[104:119], v[44:47], v[48:51], v[104:119]
    ds_write_b32 v13, v14
    v_mfma_f32_32x32x16_bf16 v[152:167], v[44:47], v[52:55], v[152:167]
    s_waitcnt lgkmcnt(6)
    s_nop 0
    v_mfma_f32_32x32x16_bf16 v[72:87], v[16:19], v[28:31], v[72:87]
    ds_read_b128 v[48:51], v6
    ds_read_b64_tr_b16 v[36:37], v4 offset:3072
    ds_read_b64_tr_b16 v[38:39], v4 offset:3840
    ds_read_b128 v[52:55], v6 offset:4096
    s_waitcnt lgkmcnt(9)
    s_nop 0
    v_mfma_f32_32x32x16_bf16 v[120:135], v[16:19], v[32:35], v[120:135]
    ds_read_b64_tr_b16 v[40:41], v4 offset:3104
    ds_read_b64_tr_b16 v[42:43], v4 offset:3872
    ds_read_b64_tr_b16 v[44:45], v4 offset:3136
    ds_read_b64_tr_b16 v[46:47], v4 offset:3904
    v_mfma_f32_16x16x32_bf16 v[68:71], v[56:59], v[16:19], v[68:71]
    s_waitcnt lgkmcnt(11)
    s_nop 0
    v_mfma_f32_32x32x16_bf16 v[88:103], v[20:23], v[28:31], v[88:103]
    v_mfma_f32_32x32x16_bf16 v[136:151], v[20:23], v[32:35], v[136:151]
    v_mfma_f32_16x16x32_bf16 v[68:71], v[60:63], v[20:23], v[68:71]
    s_waitcnt lgkmcnt(9)
    s_nop 0
    v_mfma_f32_32x32x16_bf16 v[104:119], v[24:27], v[28:31], v[104:119]
    v_mfma_f32_32x32x16_bf16 v[152:167], v[24:27], v[32:35], v[152:167]
    v_mfma_f32_16x16x32_bf16 v[68:71], v[64:67], v[24:27], v[68:71]
    s_waitcnt lgkmcnt(5)
    s_nop 0
    v_mfma_f32_32x32x16_bf16 v[72:87], v[36:39], v[48:51], v[72:87]
    ds_read_b128 v[28:31], v9
    ds_read_b64_tr_b16 v[16:17], v11 offset:0
    ds_read_b64_tr_b16 v[18:19], v11 offset:768
    ds_read_b128 v[32:35], v9 offset:4096
    s_waitcnt lgkmcnt(8)
    s_nop 0
    v_mfma_f32_32x32x16_bf16 v[120:135], v[36:39], v[52:55], v[120:135]
    ds_read_b64_tr_b16 v[20:21], v11 offset:32
    ds_read_b64_tr_b16 v[22:23], v11 offset:800
    ds_read_b64_tr_b16 v[24:25], v11 offset:64
    ds_read_b64_tr_b16 v[26:27], v11 offset:832
    v_mfma_f32_16x16x32_bf16 v[68:71], v[56:59], v[36:39], v[68:71]
    s_waitcnt lgkmcnt(10)
    s_nop 0
    v_mfma_f32_32x32x16_bf16 v[88:103], v[40:43], v[48:51], v[88:103]
    v_mfma_f32_32x32x16_bf16 v[136:151], v[40:43], v[52:55], v[136:151]
    v_mfma_f32_16x16x32_bf16 v[68:71], v[60:63], v[40:43], v[68:71]
    s_waitcnt lgkmcnt(8)
    s_nop 0
    v_mfma_f32_32x32x16_bf16 v[104:119], v[44:47], v[48:51], v[104:119]
    v_mfma_f32_32x32x16_bf16 v[152:167], v[44:47], v[52:55], v[152:167]
    v_mfma_f32_16x16x32_bf16 v[68:71], v[64:67], v[44:47], v[68:71]
    s_waitcnt lgkmcnt(5)
    s_nop 0
    v_mfma_f32_32x32x16_bf16 v[72:87], v[16:19], v[28:31], v[72:87]
    ds_read_b128 v[48:51], v10
    ds_read_b64_tr_b16 v[36:37], v11 offset:3072
    ds_read_b64_tr_b16 v[38:39], v11 offset:3840
    ds_read_b128 v[52:55], v10 offset:4096
    ds_read_b64_tr_b16 v[40:41], v11 offset:3104
    s_waitcnt lgkmcnt(9)
    s_nop 0
    v_mfma_f32_32x32x16_bf16 v[120:135], v[16:19], v[32:35], v[120:135]
    ds_read_b64_tr_b16 v[42:43], v11 offset:3872
    ds_read_b64_tr_b16 v[44:45], v11 offset:3136
    ds_read_b64_tr_b16 v[46:47], v11 offset:3904
    v_and_b32 v1, 15, v0
    v_lshl_add_u32 v1, v1, 3, s70
    s_waitcnt lgkmcnt(10)
    v_mfma_f32_32x32x16_bf16 v[88:103], v[20:23], v[28:31], v[88:103]
    v_lshrrev_b32 v3, 4, v0
    v_lshl_add_u32 v1, v3, 9, v1
    v_cmp_gt_u32 vcc, 48, v0
    v_mov_b32 v2, 148800
    s_nop 0
    v_cndmask_b32 v1, v2, v1, vcc
    v_mfma_f32_32x32x16_bf16 v[136:151], v[20:23], v[32:35], v[136:151]
    v_and_b32 v58, 0xffff0000, v68
    v_sub_f32 v58, v68, v58
    v_and_b32 v59, 0xffff0000, v58
    v_sub_f32 v59, v58, v59
    v_perm_b32 v56, v58, v68, s68
    s_waitcnt lgkmcnt(8)
    v_mfma_f32_32x32x16_bf16 v[104:119], v[24:27], v[28:31], v[104:119]
    v_lshrrev_b32 v57, 16, v59
    ds_write_b64 v1, v[56:57] offset:0
    v_and_b32 v62, 0xffff0000, v69
    v_sub_f32 v62, v69, v62
    v_and_b32 v63, 0xffff0000, v62
    v_mfma_f32_32x32x16_bf16 v[152:167], v[24:27], v[32:35], v[152:167]
    v_sub_f32 v63, v62, v63
    v_perm_b32 v60, v62, v69, s68
    v_lshrrev_b32 v61, 16, v63
    ds_write_b64 v1, v[60:61] offset:128
    v_mov_b32 v14, 11
    ds_write_b32 v13, v14
    s_waitcnt lgkmcnt(3)
    v_mfma_f32_32x32x16_bf16 v[72:87], v[36:39], v[48:51], v[72:87]
    v_mov_b32 v1, s74
    v_mov_b32 v2, s75
    v_cmp_gt_u32 vcc, 32, v0
    v_and_b32 v10, 31, v0
    s_nop 0
    v_cndmask_b32 v1, v2, v1, vcc
    v_lshl_add_u32 v13, v10, 3, s72
    v_lshl_add_u32 v14, v0, 3, s73
    v_lshrrev_b32 v11, 5, v0
    v_mfma_f32_32x32x16_bf16 v[120:135], v[36:39], v[52:55], v[120:135]
    v_lshrrev_b32 v12, 4, v10
    v_mul_u32_u24 v12, 49152, v12
    v_lshl_add_u32 v12, v11, 8, v12
    v_and_b32 v10, 15, v10
    v_lshl_add_u32 v12, v10, 4, v12
    v_mov_b32 v18, 0
    v_mov_b32 v19, 0
    v_mov_b32 v22, 0
    v_mfma_f32_32x32x16_bf16 v[88:103], v[40:43], v[48:51], v[88:103]
    v_mov_b32 v23, 0
    v_mov_b32 v26, 0
    v_mov_b32 v27, 0
    v_mov_b32 v30, 0
    v_mov_b32 v31, 0
    v_mov_b32 v34, 0
    v_mov_b32 v35, 0
L1gx:
    ds_read_b32 v2, v1 offset:0
    s_waitcnt lgkmcnt(0)
    v_cmp_gt_u32 vcc, 11, v2
    s_nop 0
    s_cmp_eq_u64 vcc, 0
    s_cbranch_scc1 L1gxk
    s_add_u32 s93, s93, 1
    s_cmp_gt_u32 s93, 0x80000
    s_cbranch_scc1 L1gxk
    s_sleep 1
    s_branch L1gx
L1gxk:
    s_nop 0
    ds_read_b64 v[16:17], v14 offset:0
    ds_read_b64 v[20:21], v14 offset:512
    ds_read_b64 v[24:25], v14 offset:1024
    ds_read_b64 v[2:3], v13
    ds_read_b64 v[8:9], v13 offset:256
    v_mfma_f32_32x32x16_bf16 v[136:151], v[40:43], v[52:55], v[136:151]
    v_mfma_f32_32x32x16_bf16 v[104:119], v[44:47], v[48:51], v[104:119]
    v_mfma_f32_32x32x16_bf16 v[152:167], v[44:47], v[52:55], v[152:167]
    s_waitcnt lgkmcnt(0)
    v_lshrrev_b32 v29, 16, v2
    v_xor_b32 v29, 0x8000, v29
    v_lshl_or_b32 v28, v29, 16, v29
    v_lshrrev_b32_e64 v33, 16, v8
    v_xor_b32 v33, 0x8000, v33
    v_lshl_or_b32 v32, v33, 16, v33
    v_mfma_f32_32x32x16_bf16 v[72:87], v[16:19], v[28:31], v[72:87]
    v_rcp_f32 v4, v3
    v_mov_b32 v6, v3
    v_mfma_f32_32x32x16_bf16 v[120:135], v[16:19], v[32:35], v[120:135]
    v_mul_f32 v4, 0xbfb8aa3b, v4
    v_rcp_f32 v10, v9
    v_mfma_f32_32x32x16_bf16 v[88:103], v[20:23], v[28:31], v[88:103]
    v_mov_b32 v14, v9
    v_mul_f32 v10, 0xbfb8aa3b, v10
    v_mfma_f32_32x32x16_bf16 v[136:151], v[20:23], v[32:35], v[136:151]
    v_mfma_f32_32x32x16_bf16 v[104:119], v[24:27], v[28:31], v[104:119]
    v_mfma_f32_32x32x16_bf16 v[152:167], v[24:27], v[32:35], v[152:167]
    s_nop 0
    s_nop 0
    v_pk_mul_f32 v[36:37], v[4:5], v[72:73] op_sel_hi:[0,1]
    v_pk_mul_f32 v[38:39], v[4:5], v[74:75] op_sel_hi:[0,1]
    v_pk_mul_f32 v[40:41], v[4:5], v[76:77] op_sel_hi:[0,1]
    v_pk_mul_f32 v[42:43], v[4:5], v[78:79] op_sel_hi:[0,1]
    v_exp_f32 v36, v36
    v_exp_f32 v37, v37
    v_exp_f32 v38, v38
    v_exp_f32 v39, v39
    v_exp_f32 v40, v40
    v_exp_f32 v41, v41
    v_exp_f32 v42, v42
    v_exp_f32 v43, v43
    v_pk_fma_f32 v[36:37], v[36:37], v[6:7], v[6:7] op_sel_hi:[1,0,0]
    v_pk_fma_f32 v[38:39], v[38:39], v[6:7], v[6:7] op_sel_hi:[1,0,0]
    v_pk_fma_f32 v[40:41], v[40:41], v[6:7], v[6:7] op_sel_hi:[1,0,0]
    v_pk_fma_f32 v[42:43], v[42:43], v[6:7], v[6:7] op_sel_hi:[1,0,0]
    v_rcp_f32 v36, v36
    v_rcp_f32 v37, v37
    v_rcp_f32 v38, v38
    v_rcp_f32 v39, v39
    v_rcp_f32 v40, v40
    v_rcp_f32 v41, v41
    v_rcp_f32 v42, v42
    v_rcp_f32 v43, v43
    v_pk_mul_f32 v[36:37], v[36:37], v[80:81]
    v_pk_mul_f32 v[38:39], v[38:39], v[82:83]
    v_pk_mul_f32 v[40:41], v[40:41], v[84:85]
    v_pk_mul_f32 v[42:43], v[42:43], v[86:87]
    v_cvt_pk_bf16_f32 v44, v36, v37
    v_cvt_pk_bf16_f32 v45, v38, v39
    v_cvt_pk_bf16_f32 v46, v40, v41
    v_cvt_pk_bf16_f32 v47, v42, v43
    buffer_store_dwordx4 v[44:47], v12, s[16:19], s64 offen offset:0 sc1
    v_pk_mul_f32 v[48:49], v[10:11], v[120:121] op_sel_hi:[0,1]
    v_pk_mul_f32 v[50:51], v[10:11], v[122:123] op_sel_hi:[0,1]
    v_pk_mul_f32 v[52:53], v[10:11], v[124:125] op_sel_hi:[0,1]
    v_pk_mul_f32 v[54:55], v[10:11], v[126:127] op_sel_hi:[0,1]
    v_exp_f32 v48, v48
    v_exp_f32 v49, v49
    v_exp_f32 v50, v50
    v_exp_f32 v51, v51
    v_exp_f32 v52, v52
    v_exp_f32 v53, v53
    v_exp_f32 v54, v54
    v_exp_f32 v55, v55
    v_pk_fma_f32 v[48:49], v[48:49], v[14:15], v[14:15] op_sel_hi:[1,0,0]
    v_pk_fma_f32 v[50:51], v[50:51], v[14:15], v[14:15] op_sel_hi:[1,0,0]
    v_pk_fma_f32 v[52:53], v[52:53], v[14:15], v[14:15] op_sel_hi:[1,0,0]
    v_pk_fma_f32 v[54:55], v[54:55], v[14:15], v[14:15] op_sel_hi:[1,0,0]
    v_rcp_f32 v48, v48
    v_rcp_f32 v49, v49
    v_rcp_f32 v50, v50
    v_rcp_f32 v51, v51
    v_rcp_f32 v52, v52
    v_rcp_f32 v53, v53
    v_rcp_f32 v54, v54
    v_rcp_f32 v55, v55
    v_pk_mul_f32 v[48:49], v[48:49], v[128:129]
    v_pk_mul_f32 v[50:51], v[50:51], v[130:131]
    v_pk_mul_f32 v[52:53], v[52:53], v[132:133]
    v_pk_mul_f32 v[54:55], v[54:55], v[134:135]
    v_cvt_pk_bf16_f32 v56, v48, v49
    v_cvt_pk_bf16_f32 v57, v50, v51
    v_cvt_pk_bf16_f32 v58, v52, v53
    v_cvt_pk_bf16_f32 v59, v54, v55
    buffer_store_dwordx4 v[56:59], v12, s[16:19], s65 offen offset:0 sc1
    v_pk_mul_f32 v[36:37], v[4:5], v[88:89] op_sel_hi:[0,1]
    v_pk_mul_f32 v[38:39], v[4:5], v[90:91] op_sel_hi:[0,1]
    v_pk_mul_f32 v[40:41], v[4:5], v[92:93] op_sel_hi:[0,1]
    v_pk_mul_f32 v[42:43], v[4:5], v[94:95] op_sel_hi:[0,1]
    v_exp_f32 v36, v36
    v_exp_f32 v37, v37
    v_exp_f32 v38, v38
    v_exp_f32 v39, v39
    v_exp_f32 v40, v40
    v_exp_f32 v41, v41
    v_exp_f32 v42, v42
    v_exp_f32 v43, v43
    v_pk_fma_f32 v[36:37], v[36:37], v[6:7], v[6:7] op_sel_hi:[1,0,0]
    v_pk_fma_f32 v[38:39], v[38:39], v[6:7], v[6:7] op_sel_hi:[1,0,0]
    v_pk_fma_f32 v[40:41], v[40:41], v[6:7], v[6:7] op_sel_hi:[1,0,0]
    v_pk_fma_f32 v[42:43], v[42:43], v[6:7], v[6:7] op_sel_hi:[1,0,0]
    v_rcp_f32 v36, v36
    v_rcp_f32 v37, v37
    v_rcp_f32 v38, v38
    v_rcp_f32 v39, v39
    v_rcp_f32 v40, v40
    v_rcp_f32 v41, v41
    v_rcp_f32 v42, v42
    v_rcp_f32 v43, v43
    v_pk_mul_f32 v[36:37], v[36:37], v[96:97]
    v_pk_mul_f32 v[38:39], v[38:39], v[98:99]
    v_pk_mul_f32 v[40:41], v[40:41], v[100:101]
    v_pk_mul_f32 v[42:43], v[42:43], v[102:103]
    v_cvt_pk_bf16_f32 v44, v36, v37
    v_cvt_pk_bf16_f32 v45, v38, v39
    v_cvt_pk_bf16_f32 v46, v40, v41
    v_cvt_pk_bf16_f32 v47, v42, v43
    buffer_store_dwordx4 v[44:47], v12, s[16:19], s64 offen offset:512 sc1
    v_pk_mul_f32 v[48:49], v[10:11], v[136:137] op_sel_hi:[0,1]
    v_pk_mul_f32 v[50:51], v[10:11], v[138:139] op_sel_hi:[0,1]
    v_pk_mul_f32 v[52:53], v[10:11], v[140:141] op_sel_hi:[0,1]
    v_pk_mul_f32 v[54:55], v[10:11], v[142:143] op_sel_hi:[0,1]
    v_exp_f32 v48, v48
    v_exp_f32 v49, v49
    v_exp_f32 v50, v50
    v_exp_f32 v51, v51
    v_exp_f32 v52, v52
    v_exp_f32 v53, v53
    v_exp_f32 v54, v54
    v_exp_f32 v55, v55
    v_pk_fma_f32 v[48:49], v[48:49], v[14:15], v[14:15] op_sel_hi:[1,0,0]
    v_pk_fma_f32 v[50:51], v[50:51], v[14:15], v[14:15] op_sel_hi:[1,0,0]
    v_pk_fma_f32 v[52:53], v[52:53], v[14:15], v[14:15] op_sel_hi:[1,0,0]
    v_pk_fma_f32 v[54:55], v[54:55], v[14:15], v[14:15] op_sel_hi:[1,0,0]
    v_rcp_f32 v48, v48
    v_rcp_f32 v49, v49
    v_rcp_f32 v50, v50
    v_rcp_f32 v51, v51
    v_rcp_f32 v52, v52
    v_rcp_f32 v53, v53
    v_rcp_f32 v54, v54
    v_rcp_f32 v55, v55
    v_pk_mul_f32 v[48:49], v[48:49], v[144:145]
    v_pk_mul_f32 v[50:51], v[50:51], v[146:147]
    v_pk_mul_f32 v[52:53], v[52:53], v[148:149]
    v_pk_mul_f32 v[54:55], v[54:55], v[150:151]
    v_cvt_pk_bf16_f32 v56, v48, v49
    v_cvt_pk_bf16_f32 v57, v50, v51
    v_cvt_pk_bf16_f32 v58, v52, v53
    v_cvt_pk_bf16_f32 v59, v54, v55
    buffer_store_dwordx4 v[56:59], v12, s[16:19], s65 offen offset:512 sc1
    v_pk_mul_f32 v[36:37], v[4:5], v[104:105] op_sel_hi:[0,1]
    v_pk_mul_f32 v[38:39], v[4:5], v[106:107] op_sel_hi:[0,1]
    v_pk_mul_f32 v[40:41], v[4:5], v[108:109] op_sel_hi:[0,1]
    v_pk_mul_f32 v[42:43], v[4:5], v[110:111] op_sel_hi:[0,1]
    v_exp_f32 v36, v36
    v_exp_f32 v37, v37
    v_exp_f32 v38, v38
    v_exp_f32 v39, v39
    v_exp_f32 v40, v40
    v_exp_f32 v41, v41
    v_exp_f32 v42, v42
    v_exp_f32 v43, v43
    v_pk_fma_f32 v[36:37], v[36:37], v[6:7], v[6:7] op_sel_hi:[1,0,0]
    v_pk_fma_f32 v[38:39], v[38:39], v[6:7], v[6:7] op_sel_hi:[1,0,0]
    v_pk_fma_f32 v[40:41], v[40:41], v[6:7], v[6:7] op_sel_hi:[1,0,0]
    v_pk_fma_f32 v[42:43], v[42:43], v[6:7], v[6:7] op_sel_hi:[1,0,0]
    v_rcp_f32 v36, v36
    v_rcp_f32 v37, v37
    v_rcp_f32 v38, v38
    v_rcp_f32 v39, v39
    v_rcp_f32 v40, v40
    v_rcp_f32 v41, v41
    v_rcp_f32 v42, v42
    v_rcp_f32 v43, v43
    v_pk_mul_f32 v[36:37], v[36:37], v[112:113]
    v_pk_mul_f32 v[38:39], v[38:39], v[114:115]
    v_pk_mul_f32 v[40:41], v[40:41], v[116:117]
    v_pk_mul_f32 v[42:43], v[42:43], v[118:119]
    v_cvt_pk_bf16_f32 v44, v36, v37
    v_cvt_pk_bf16_f32 v45, v38, v39
    v_cvt_pk_bf16_f32 v46, v40, v41
    v_cvt_pk_bf16_f32 v47, v42, v43
    buffer_store_dwordx4 v[44:47], v12, s[16:19], s64 offen offset:1024 sc1
    v_pk_mul_f32 v[48:49], v[10:11], v[152:153] op_sel_hi:[0,1]
    v_pk_mul_f32 v[50:51], v[10:11], v[154:155] op_sel_hi:[0,1]
    v_pk_mul_f32 v[52:53], v[10:11], v[156:157] op_sel_hi:[0,1]
    v_pk_mul_f32 v[54:55], v[10:11], v[158:159] op_sel_hi:[0,1]
    v_exp_f32 v48, v48
    v_exp_f32 v49, v49
    v_exp_f32 v50, v50
    v_exp_f32 v51, v51
    v_exp_f32 v52, v52
    v_exp_f32 v53, v53
    v_exp_f32 v54, v54
    v_exp_f32 v55, v55
    v_pk_fma_f32 v[48:49], v[48:49], v[14:15], v[14:15] op_sel_hi:[1,0,0]
    v_pk_fma_f32 v[50:51], v[50:51], v[14:15], v[14:15] op_sel_hi:[1,0,0]
    v_pk_fma_f32 v[52:53], v[52:53], v[14:15], v[14:15] op_sel_hi:[1,0,0]
    v_pk_fma_f32 v[54:55], v[54:55], v[14:15], v[14:15] op_sel_hi:[1,0,0]
    v_rcp_f32 v48, v48
    v_rcp_f32 v49, v49
    v_rcp_f32 v50, v50
    v_rcp_f32 v51, v51
    v_rcp_f32 v52, v52
    v_rcp_f32 v53, v53
    v_rcp_f32 v54, v54
    v_rcp_f32 v55, v55
    v_pk_mul_f32 v[48:49], v[48:49], v[160:161]
    v_pk_mul_f32 v[50:51], v[50:51], v[162:163]
    v_pk_mul_f32 v[52:53], v[52:53], v[164:165]
    v_pk_mul_f32 v[54:55], v[54:55], v[166:167]
    v_cvt_pk_bf16_f32 v56, v48, v49
    v_cvt_pk_bf16_f32 v57, v50, v51
    v_cvt_pk_bf16_f32 v58, v52, v53
    v_cvt_pk_bf16_f32 v59, v54, v55
    buffer_store_dwordx4 v[56:59], v12, s[16:19], s65 offen offset:1024 sc1
    s_endpgm
L1slowmid:
    s_waitcnt lgkmcnt(0)
    ds_write_b32 v13, v14
    s_add_u32 s92, s92, 1
    ds_read_b32 v12, v13 offset:3072
    s_waitcnt lgkmcnt(0)
    v_cmp_ge_u32 vcc, s28, v12
    s_nop 0
    s_cmp_eq_u64 vcc, 0
    s_cbranch_scc1 L1backmid
    s_add_u32 s93, s93, 1
    s_cmp_gt_u32 s93, 0x80000
    s_cbranch_scc1 L1backmid
    s_sleep 1
    s_branch L1slowmid
L1slowlast:
    s_waitcnt lgkmcnt(0)
    ds_write_b32 v13, v14
    s_add_u32 s92, s92, 1
    ds_read_b32 v12, v13 offset:3072
    s_waitcnt lgkmcnt(0)
    v_cmp_ge_u32 vcc, s28, v12
    s_nop 0
    s_cmp_eq_u64 vcc, 0
    s_cbranch_scc1 L1backlast
    s_add_u32 s93, s93, 1
    s_cmp_gt_u32 s93, 0x80000
    s_cbranch_scc1 L1backlast
    s_sleep 1
    s_branch L1slowlast
L1misc:
    s_lshr_b32 s3, s3, 3
    v_lshrrev_b32 v1, 4, v0
    v_and_b32 v2, 15, v0
    v_mul_u32_u24 v3, 1280, v1
    v_lshl_add_u32 v3, v2, 4, v3
    s_lshl_b32 s64, s4, 7
    s_lshl_b32 s65, s5, 3
    s_add_u32 s64, s64, s65
    s_lshl_b32 s65, s3, 2
    s_add_u32 s64, s64, s65
    s_mul_i32 s65, s64, 1280
    s_lshl_b32 s66, s64, 3
    s_add_u32 s66, s66, 0
    v_lshlrev_b32 v4, 3, v1
    s_sub_u32 s67, s5, 4
    s_lshr_b32 s75, s67, 1
    s_add_u32 s75, s75, 4
    s_and_b32 s67, s67, 1
    s_lshl_b32 s67, s67, 6
    s_lshl_b32 s77, s3, 5
    s_add_u32 s77, s77, s67
    s_lshl_b32 s67, s3, 6
    s_cmp_lt_u32 s5, 4
    s_cselect_b32 s75, s5, s75
    s_cselect_b32 s77, s67, s77
    s_cselect_b32 s78, 1, 0
    s_lshl_b32 s67, s3, 8
    s_add_u32 s67, s67, 150336
    v_lshl_add_u32 v124, v0, 2, s67
    v_mov_b32 v125, s75
    v_lshlrev_b32 v126, 2, v0
    v_add_u32 v126, 152384, v126
    v_mov_b32 v5, 0
    s_lshr_b32 s69, s2, 3
    s_lshl_b32 s70, s60, 5
    s_add_u32 s69, s69, s70
    s_mul_i32 s70, s69, 3072
    v_mul_u32_u24 v10, 43691, v0
    v_lshrrev_b32 v10, 19, v10
    v_mul_u32_u24 v11, 12, v10
    v_sub_u32 v11, v0, v11
    v_mul_u32_u24 v10, 196608, v10
    v_lshl_add_u32 v127, v11, 6, v10
    s_mul_i32 s71, s61, 768
    s_add_u32 s71, s71, s70
    s_cmp_eq_u32 s3, 1
    s_waitcnt lgkmcnt(0)
    s_cselect_b32 s24, s50, s48
    s_cselect_b32 s25, s51, s49
    s_nop 0
    s_mov_b32 s26, 1966080
    s_mov_b32 s27, 0x20000
    ds_write_b32 v124, v125
    s_mov_b32 s8, s32
    s_mov_b32 s9, s33
    s_mov_b32 s10, 2621440
    s_mov_b32 s11, 0x20000
    s_mov_b32 s16, s58
    s_mov_b32 s17, s59
    s_mov_b32 s18, 268435456
    s_mov_b32 s19, 0x20000
    s_mov_b32 s20, s56
    s_mov_b32 s21, s57
    s_mov_b32 s22, 256
    s_mov_b32 s23, 0x20000
    buffer_load_dwordx4 v[16:19], v3, s[8:11], s65 offen offset:0
    buffer_load_dwordx4 v[20:23], v3, s[8:11], s65 offen offset:256
    s_and_b32 s67, s2, 31
    s_or_b32 s67, s67, s3
    s_cmp_lg_u32 s67, 0
    s_cbranch_scc1 L1nononce
    s_memrealtime s[72:73]
    v_mov_b32 v7, 0
    s_waitcnt lgkmcnt(0)
    s_or_b32 s72, s72, 1
    v_mov_b32 v6, s72
    s_mov_b64 exec, 1
    buffer_atomic_cmpswap v[6:7], v5, s[20:23], 0 offen sc1
    s_mov_b64 exec, -1
L1nononce:
    v_bfe_u32 v116, v0, 2, 2
    v_lshrrev_b32 v117, 4, v0
    v_lshl_add_u32 v118, v117, 3, v116
    v_lshlrev_b32 v118, 7, v118
    v_and_b32 v119, 1, v0
    v_lshl_add_u32 v118, v119, 3, v118
    v_and_b32 v117, 1, v117
    v_lshlrev_b32 v117, 2, v117
    v_lshrrev_b32 v116, 1, v116
    v_or_b32 v117, v117, v116
    v_bfe_u32 v119, v0, 1, 1
    v_xor_b32 v117, v117, v119
    s_mul_i32 s73, s75, 43
    s_lshr_b32 s73, s73, 7
    s_mul_i32 s73, s73, 3
    s_sub_u32 s73, s75, s73
    s_mul_i32 s73, s73, 41088
    s_lshl_b32 s74, s77, 7
    s_add_u32 s73, s73, s74
    v_add_u32 v118, s73, v118
    s_add_u32 s79, s75, 1
    v_mov_b32 v125, 100
    v_xor_b32 v116, 0, v117
    v_lshl_add_u32 v120, v116, 4, v118
    v_xor_b32 v116, 2, v117
    v_lshl_add_u32 v121, v116, 4, v118
    v_xor_b32 v116, 4, v117
    v_lshl_add_u32 v122, v116, 4, v118
    v_xor_b32 v116, 6, v117
    v_lshl_add_u32 v123, v116, 4, v118
L1mw0:
    ds_read_b32 v116, v126 offset:0
    s_waitcnt lgkmcnt(0)
    v_cmp_gt_u32 vcc, 1, v116
    s_nop 0
    s_cmp_eq_u64 vcc, 0
    s_cbranch_scc1 L1mw0k
    s_add_u32 s93, s93, 1
    s_cmp_gt_u32 s93, 0x80000
    s_cbranch_scc1 L1mw0k
    s_sleep 2
    s_branch L1mw0
L1mw0k:
    s_nop 0
    buffer_load_dwordx4 v[24:27], v3, s[8:11], s65 offen offset:512
    buffer_load_dwordx4 v[28:31], v3, s[8:11], s65 offen offset:768
    s_add_u32 s70, s71, 786432
    s_mov_b32 exec_lo, 4294967295
    s_mov_b32 exec_hi, 15
    buffer_load_dword v128, v127, s[24:27], s70 offen sc1
    s_mov_b64 exec, -1
    s_cmp_lt_u32 s75, 0
    s_cbranch_scc1 L1nocap0
    s_cmp_gt_u32 s75, 0
    s_cbranch_scc1 L1nocap0
    s_nop 0
    ds_read_b64_tr_b16 v[84:85], v120 offset:0
    ds_read_b64_tr_b16 v[86:87], v121 offset:512
    ds_read_b64_tr_b16 v[88:89], v121 offset:0
    ds_read_b64_tr_b16 v[90:91], v120 offset:512
    ds_read_b64_tr_b16 v[92:93], v122 offset:0
    ds_read_b64_tr_b16 v[94:95], v123 offset:512
    ds_read_b64_tr_b16 v[96:97], v123 offset:0
    ds_read_b64_tr_b16 v[98:99], v122 offset:512
    ds_read_b64_tr_b16 v[100:101], v120 offset:4096
    ds_read_b64_tr_b16 v[102:103], v121 offset:4608
    ds_read_b64_tr_b16 v[104:105], v121 offset:4096
    ds_read_b64_tr_b16 v[106:107], v120 offset:4608
    ds_read_b64_tr_b16 v[108:109], v122 offset:4096
    ds_read_b64_tr_b16 v[110:111], v123 offset:4608
    ds_read_b64_tr_b16 v[112:113], v123 offset:4096
    ds_read_b64_tr_b16 v[114:115], v122 offset:4608
    s_waitcnt lgkmcnt(0)
    ds_write_b32 v124, v125
L1nocap0:
L1mw1:
    ds_read_b32 v116, v126 offset:0
    s_waitcnt lgkmcnt(0)
    v_cmp_gt_u32 vcc, 2, v116
    s_nop 0
    s_cmp_eq_u64 vcc, 0
    s_cbranch_scc1 L1mw1k
    s_add_u32 s93, s93, 1
    s_cmp_gt_u32 s93, 0x80000
    s_cbranch_scc1 L1mw1k
    s_sleep 2
    s_branch L1mw1
L1mw1k:
    buffer_load_dwordx4 v[32:35], v3, s[8:11], s65 offen offset:1024
    s_add_u32 s70, s71, 1376256
    s_mov_b32 exec_lo, 4294967295
    s_mov_b32 exec_hi, 15
    buffer_load_dword v128, v127, s[24:27], s70 offen sc1
    s_mov_b64 exec, -1
    buffer_load_dword v80, v5, s[20:23], 0 offen sc1
    s_cmp_lt_u32 s75, 1
    s_cbranch_scc1 L1nocap1
    s_cmp_gt_u32 s75, 2
    s_cbranch_scc1 L1nocap1
L1cw1:
    ds_read_b32 v116, v126 offset:0
    s_waitcnt lgkmcnt(0)
    v_cmp_gt_u32 vcc, s79, v116
    s_nop 0
    s_cmp_eq_u64 vcc, 0
    s_cbranch_scc1 L1cw1k
    s_add_u32 s93, s93, 1
    s_cmp_gt_u32 s93, 0x80000
    s_cbranch_scc1 L1cw1k
    s_sleep 2
    s_branch L1cw1
L1cw1k:
    ds_read_b64_tr_b16 v[84:85], v120 offset:0
    ds_read_b64_tr_b16 v[86:87], v121 offset:512
    ds_read_b64_tr_b16 v[88:89], v121 offset:0
    ds_read_b64_tr_b16 v[90:91], v120 offset:512
    ds_read_b64_tr_b16 v[92:93], v122 offset:0
    ds_read_b64_tr_b16 v[94:95], v123 offset:512
    ds_read_b64_tr_b16 v[96:97], v123 offset:0
    ds_read_b64_tr_b16 v[98:99], v122 offset:512
    ds_read_b64_tr_b16 v[100:101], v120 offset:4096
    ds_read_b64_tr_b16 v[102:103], v121 offset:4608
    ds_read_b64_tr_b16 v[104:105], v121 offset:4096
    ds_read_b64_tr_b16 v[106:107], v120 offset:4608
    ds_read_b64_tr_b16 v[108:109], v122 offset:4096
    ds_read_b64_tr_b16 v[110:111], v123 offset:4608
    ds_read_b64_tr_b16 v[112:113], v123 offset:4096
    ds_read_b64_tr_b16 v[114:115], v122 offset:4608
    s_waitcnt lgkmcnt(0)
    ds_write_b32 v124, v125
L1nocap1:
    s_waitcnt vmcnt(0)
    v_lshlrev_b32 v40, 16, v16
    v_and_b32 v41, 0xffff0000, v16
    v_lshlrev_b32 v42, 16, v17
    v_and_b32 v43, 0xffff0000, v17
    v_lshlrev_b32 v44, 16, v18
    v_and_b32 v45, 0xffff0000, v18
    v_lshlrev_b32 v46, 16, v19
    v_and_b32 v47, 0xffff0000, v19
    v_lshlrev_b32 v48, 16, v20
    v_and_b32 v49, 0xffff0000, v20
    v_lshlrev_b32 v50, 16, v21
    v_and_b32 v51, 0xffff0000, v21
    v_lshlrev_b32 v52, 16, v22
    v_and_b32 v53, 0xffff0000, v22
    v_lshlrev_b32 v54, 16, v23
    v_and_b32 v55, 0xffff0000, v23
    v_lshlrev_b32 v56, 16, v24
    v_and_b32 v57, 0xffff0000, v24
    v_lshlrev_b32 v58, 16, v25
    v_and_b32 v59, 0xffff0000, v25
    v_lshlrev_b32 v60, 16, v26
    v_and_b32 v61, 0xffff0000, v26
    v_lshlrev_b32 v62, 16, v27
    v_and_b32 v63, 0xffff0000, v27
    v_lshlrev_b32 v64, 16, v28
    v_and_b32 v65, 0xffff0000, v28
    v_lshlrev_b32 v66, 16, v29
    v_and_b32 v67, 0xffff0000, v29
    v_lshlrev_b32 v68, 16, v30
    v_and_b32 v69, 0xffff0000, v30
    v_lshlrev_b32 v70, 16, v31
    v_and_b32 v71, 0xffff0000, v31
    v_lshlrev_b32 v72, 16, v32
    v_and_b32 v73, 0xffff0000, v32
    v_lshlrev_b32 v74, 16, v33
    v_and_b32 v75, 0xffff0000, v33
    v_lshlrev_b32 v76, 16, v34
    v_and_b32 v77, 0xffff0000, v34
    v_lshlrev_b32 v78, 16, v35
    v_and_b32 v79, 0xffff0000, v35
    v_add_f32 v8, v40, v44
    v_add_f32 v9, v41, v45
    v_add_f32 v10, v42, v46
    v_add_f32 v11, v43, v47
    v_add_f32 v8, v8, v48
    v_add_f32 v9, v9, v49
    v_add_f32 v10, v10, v50
    v_add_f32 v11, v11, v51
    v_add_f32 v8, v8, v52
    v_add_f32 v9, v9, v53
    v_add_f32 v10, v10, v54
    v_add_f32 v11, v11, v55
    v_add_f32 v8, v8, v56
    v_add_f32 v9, v9, v57
    v_add_f32 v10, v10, v58
    v_add_f32 v11, v11, v59
    v_add_f32 v8, v8, v60
    v_add_f32 v9, v9, v61
    v_add_f32 v10, v10, v62
    v_add_f32 v11, v11, v63
    v_add_f32 v8, v8, v64
    v_add_f32 v9, v9, v65
    v_add_f32 v10, v10, v66
    v_add_f32 v11, v11, v67
    v_add_f32 v8, v8, v68
    v_add_f32 v9, v9, v69
    v_add_f32 v10, v10, v70
    v_add_f32 v11, v11, v71
    v_add_f32 v8, v8, v72
    v_add_f32 v9, v9, v73
    v_add_f32 v10, v10, v74
    v_add_f32 v11, v11, v75
    v_add_f32 v8, v8, v76
    v_add_f32 v9, v9, v77
    v_add_f32 v10, v10, v78
    v_add_f32 v11, v11, v79
    v_add_f32 v8, v8, v9
    v_add_f32 v10, v10, v11
    v_add_f32 v8, v8, v10
    s_nop 1
    v_add_f32_dpp v8, v8, v8 quad_perm:[1,0,3,2] row_mask:0xf bank_mask:0xf
    s_nop 1
    v_add_f32_dpp v8, v8, v8 quad_perm:[2,3,0,1] row_mask:0xf bank_mask:0xf
    s_nop 1
    v_add_f32_dpp v8, v8, v8 row_half_mirror row_mask:0xf bank_mask:0xf
    s_nop 1
    v_add_f32_dpp v8, v8, v8 row_mirror row_mask:0xf bank_mask:0xf
    v_mul_f32 v8, 0x3acccccd, v8
    v_sub_f32 v40, v40, v8
    v_sub_f32 v41, v41, v8
    v_sub_f32 v42, v42, v8
    v_sub_f32 v43, v43, v8
    v_sub_f32 v44, v44, v8
    v_sub_f32 v45, v45, v8
    v_sub_f32 v46, v46, v8
    v_sub_f32 v47, v47, v8
    v_sub_f32 v48, v48, v8
    v_sub_f32 v49, v49, v8
    v_sub_f32 v50, v50, v8
    v_sub_f32 v51, v51, v8
    v_sub_f32 v52, v52, v8
    v_sub_f32 v53, v53, v8
    v_sub_f32 v54, v54, v8
    v_sub_f32 v55, v55, v8
    v_sub_f32 v56, v56, v8
    v_sub_f32 v57, v57, v8
    v_sub_f32 v58, v58, v8
    v_sub_f32 v59, v59, v8
    v_sub_f32 v60, v60, v8
    v_sub_f32 v61, v61, v8
    v_sub_f32 v62, v62, v8
    v_sub_f32 v63, v63, v8
    v_sub_f32 v64, v64, v8
    v_sub_f32 v65, v65, v8
    v_sub_f32 v66, v66, v8
    v_sub_f32 v67, v67, v8
    v_sub_f32 v68, v68, v8
    v_sub_f32 v69, v69, v8
    v_sub_f32 v70, v70, v8
    v_sub_f32 v71, v71, v8
    v_sub_f32 v72, v72, v8
    v_sub_f32 v73, v73, v8
    v_sub_f32 v74, v74, v8
    v_sub_f32 v75, v75, v8
    v_sub_f32 v76, v76, v8
    v_sub_f32 v77, v77, v8
    v_sub_f32 v78, v78, v8
    v_sub_f32 v79, v79, v8
    v_mul_f32 v10, v40, v40
    v_mul_f32 v11, v41, v41
    v_mul_f32 v12, v42, v42
    v_mul_f32 v13, v43, v43
    v_fmac_f32 v10, v44, v44
    v_fmac_f32 v11, v45, v45
    v_fmac_f32 v12, v46, v46
    v_fmac_f32 v13, v47, v47
    v_fmac_f32 v10, v48, v48
    v_fmac_f32 v11, v49, v49
    v_fmac_f32 v12, v50, v50
    v_fmac_f32 v13, v51, v51
    v_fmac_f32 v10, v52, v52
    v_fmac_f32 v11, v53, v53
    v_fmac_f32 v12, v54, v54
    v_fmac_f32 v13, v55, v55
    v_fmac_f32 v10, v56, v56
    v_fmac_f32 v11, v57, v57
    v_fmac_f32 v12, v58, v58
    v_fmac_f32 v13, v59, v59
    v_fmac_f32 v10, v60, v60
    v_fmac_f32 v11, v61, v61
    v_fmac_f32 v12, v62, v62
    v_fmac_f32 v13, v63, v63
    v_fmac_f32 v10, v64, v64
    v_fmac_f32 v11, v65, v65
    v_fmac_f32 v12, v66, v66
    v_fmac_f32 v13, v67, v67
    v_fmac_f32 v10, v68, v68
    v_fmac_f32 v11, v69, v69
    v_fmac_f32 v12, v70, v70
    v_fmac_f32 v13, v71, v71
    v_fmac_f32 v10, v72, v72
    v_fmac_f32 v11, v73, v73
    v_fmac_f32 v12, v74, v74
    v_fmac_f32 v13, v75, v75
    v_fmac_f32 v10, v76, v76
    v_fmac_f32 v11, v77, v77
    v_fmac_f32 v12, v78, v78
    v_fmac_f32 v13, v79, v79
    v_add_f32 v10, v10, v11
    v_add_f32 v12, v12, v13
    v_add_f32 v9, v10, v12
    s_nop 1
    v_add_f32_dpp v9, v9, v9 quad_perm:[1,0,3,2] row_mask:0xf bank_mask:0xf
    s_nop 1
    v_add_f32_dpp v9, v9, v9 quad_perm:[2,3,0,1] row_mask:0xf bank_mask:0xf
    s_nop 1
    v_add_f32_dpp v9, v9, v9 row_half_mirror row_mask:0xf bank_mask:0xf
    s_nop 1
    v_add_f32_dpp v9, v9, v9 row_mirror row_mask:0xf bank_mask:0xf
    v_mul_f32 v9, 0x3acccccd, v9
    v_cvt_pk_bf16_f32 v8, v8, v8
    v_lshlrev_b32 v8, 16, v8
    v_cvt_pk_bf16_f32 v9, v9, v9
    v_lshlrev_b32 v9, 16, v9
    v_add_f32 v9, 0x3727c5ac, v9
    v_cvt_pk_bf16_f32 v9, v9, v9
    v_lshlrev_b32 v9, 16, v9
    v_sqrt_f32 v9, v9
    s_nop 0
    v_cvt_pk_bf16_f32 v9, v9, v9
    v_lshlrev_b32 v9, 16, v9
    v_lshrrev_b32 v9, 16, v9
    v_or_b32 v8, v8, v9
    s_mov_b32 s71, 0
L1npoll:
    s_waitcnt vmcnt(0)
    v_readfirstlane_b32 s72, v80
    s_nop 0
    s_cmp_lg_u32 s72, 0
    s_cbranch_scc1 L1npollok
    s_add_u32 s71, s71, 1
    s_cmp_gt_u32 s71, 0x40000
    s_cbranch_scc1 L1npollok
    s_sleep 8
    buffer_load_dword v80, v5, s[20:23], 0 offen sc1
    s_branch L1npoll
L1npollok:
    v_mov_b32_e64 v9, s72
    s_mov_b32 exec_lo, 0x00010001
    s_mov_b32 exec_hi, 0x00010001
    buffer_store_dwordx2 v[8:9], v4, s[16:19], s66 offen sc1
    s_mov_b64 exec, -1
    v_mul_u32_u24 v10, 52429, v0
    v_lshrrev_b32 v10, 18, v10
    v_mul_u32_u24 v11, 5, v10
    v_sub_u32 v11, v0, v11
    v_mul_u32_u24 v10, 1280, v10
    v_lshl_add_u32 v10, v11, 7, v10
    s_lshr_b32 s70, s2, 1
    s_lshl_b32 s70, s70, 1
    s_add_u32 s70, s70, s3
    s_mul_i32 s70, s70, 10240
    s_mul_i32 s71, s60, 640
    s_add_u32 s70, s70, s71
    s_mov_b32 s24, s52
    s_mov_b32 s25, s53
    s_mov_b32 s26, 1966080
    s_mov_b32 s27, 0x20000
    s_mov_b32 exec_hi, 0xff
    buffer_load_dword v128, v10, s[24:27], s70 offen sc1
    s_mov_b64 exec, -1
    s_lshl_b32 s69, s4, 10
    s_lshl_b32 s70, s3, 9
    s_add_u32 s69, s69, s70
    s_add_u32 s69, s69, 0
    v_lshlrev_b32 v7, 3, v0
    v_add_u32 v12, s70, v7
    v_add_u32 v12, 146752, v12
    s_lshl_b32 s67, s3, 8
    s_add_u32 s67, s67, 151616
    v_lshl_add_u32 v130, v0, 2, s67
    v_mov_b32 v131, 11
    s_cmp_lt_u32 s75, 3
    s_cbranch_scc1 L1nocap2
    s_cmp_gt_u32 s75, 4
    s_cbranch_scc1 L1nocap2
L1cw2:
    ds_read_b32 v116, v126 offset:0
    s_waitcnt lgkmcnt(0)
    v_cmp_gt_u32 vcc, s79, v116
    s_nop 0
    s_cmp_eq_u64 vcc, 0
    s_cbranch_scc1 L1cw2k
    s_add_u32 s93, s93, 1
    s_cmp_gt_u32 s93, 0x80000
    s_cbranch_scc1 L1cw2k
    s_sleep 2
    s_branch L1cw2
L1cw2k:
    ds_read_b64_tr_b16 v[84:85], v120 offset:0
    ds_read_b64_tr_b16 v[86:87], v121 offset:512
    ds_read_b64_tr_b16 v[88:89], v121 offset:0
    ds_read_b64_tr_b16 v[90:91], v120 offset:512
    ds_read_b64_tr_b16 v[92:93], v122 offset:0
    ds_read_b64_tr_b16 v[94:95], v123 offset:512
    ds_read_b64_tr_b16 v[96:97], v123 offset:0
    ds_read_b64_tr_b16 v[98:99], v122 offset:512
    ds_read_b64_tr_b16 v[100:101], v120 offset:4096
    ds_read_b64_tr_b16 v[102:103], v121 offset:4608
    ds_read_b64_tr_b16 v[104:105], v121 offset:4096
    ds_read_b64_tr_b16 v[106:107], v120 offset:4608
    ds_read_b64_tr_b16 v[108:109], v122 offset:4096
    ds_read_b64_tr_b16 v[110:111], v123 offset:4608
    ds_read_b64_tr_b16 v[112:113], v123 offset:4096
    ds_read_b64_tr_b16 v[114:115], v122 offset:4608
    s_waitcnt lgkmcnt(0)
    ds_write_b32 v124, v125
L1nocap2:
L1mw2:
    ds_read_b32 v116, v126 offset:0
    s_waitcnt lgkmcnt(0)
    v_cmp_gt_u32 vcc, 6, v116
    s_nop 0
    s_cmp_eq_u64 vcc, 0
    s_cbranch_scc1 L1mw2k
    s_add_u32 s93, s93, 1
    s_cmp_gt_u32 s93, 0x80000
    s_cbranch_scc1 L1mw2k
    s_sleep 4
    s_branch L1mw2
L1mw2k:
    s_mov_b32 s71, 0
L1poll:
    buffer_load_dwordx2 v[10:11], v7, s[16:19], s69 offen sc1
    s_waitcnt vmcnt(0)
    v_cmp_ne_u32 vcc, s72, v11
    s_nop 0
    s_cmp_eq_u64 vcc, 0
    s_cbranch_scc1 L1pollok
    s_add_u32 s71, s71, 1
    s_cmp_gt_u32 s71, 0x40000
    s_cbranch_scc1 L1pollok
    s_sleep 8
    s_branch L1poll
L1pollok:
    v_and_b32 v8, 0xffff0000, v10
    v_lshlrev_b32 v9, 16, v10
    v_rcp_f32 v11, v9
    v_mov_b32_e64 v10, v8
    ds_write_b64 v12, v[8:9]
    ds_write_b64 v12, v[10:11] offset:1024
    ds_write_b32 v130, v131
    s_cmp_lt_u32 s75, 5
    s_cbranch_scc1 L1nocap3
    s_cmp_gt_u32 s75, 9
    s_cbranch_scc1 L1nocap3
L1cw3:
    ds_read_b32 v116, v126 offset:0
    s_waitcnt lgkmcnt(0)
    v_cmp_gt_u32 vcc, s79, v116
    s_nop 0
    s_cmp_eq_u64 vcc, 0
    s_cbranch_scc1 L1cw3k
    s_add_u32 s93, s93, 1
    s_cmp_gt_u32 s93, 0x80000
    s_cbranch_scc1 L1cw3k
    s_sleep 2
    s_branch L1cw3
L1cw3k:
    s_nop 0
    ds_read_b64_tr_b16 v[84:85], v120 offset:0
    ds_read_b64_tr_b16 v[86:87], v121 offset:512
    ds_read_b64_tr_b16 v[88:89], v121 offset:0
    ds_read_b64_tr_b16 v[90:91], v120 offset:512
    ds_read_b64_tr_b16 v[92:93], v122 offset:0
    ds_read_b64_tr_b16 v[94:95], v123 offset:512
    ds_read_b64_tr_b16 v[96:97], v123 offset:0
    ds_read_b64_tr_b16 v[98:99], v122 offset:512
    ds_read_b64_tr_b16 v[100:101], v120 offset:4096
    ds_read_b64_tr_b16 v[102:103], v121 offset:4608
    ds_read_b64_tr_b16 v[104:105], v121 offset:4096
    ds_read_b64_tr_b16 v[106:107], v120 offset:4608
    ds_read_b64_tr_b16 v[108:109], v122 offset:4096
    ds_read_b64_tr_b16 v[110:111], v123 offset:4608
    ds_read_b64_tr_b16 v[112:113], v123 offset:4096
    ds_read_b64_tr_b16 v[114:115], v122 offset:4608
    s_waitcnt lgkmcnt(0)
    ds_write_b32 v124, v125
L1nocap3:
    v_and_b32 v13, 1, v0
    v_lshlrev_b32 v13, 8, v13
    v_add_u32 v13, 151616, v13
L1sw:
    ds_read_b32 v116, v13 offset:0
    s_waitcnt lgkmcnt(0)
    v_cmp_gt_u32 vcc, 11, v116
    s_nop 0
    s_cmp_eq_u64 vcc, 0
    s_cbranch_scc1 L1swk
    s_add_u32 s93, s93, 1
    s_cmp_gt_u32 s93, 0x80000
    s_cbranch_scc1 L1swk
    s_sleep 1
    s_branch L1sw
L1swk:
    v_lshrrev_b32 v15, 4, v0
    s_lshl_b32 s70, s77, 3
    s_add_u32 s70, s70, 147776
    v_lshl_add_u32 v13, v15, 6, s70
    s_lshl_b32 s76, s75, 18
    s_lshl_b32 s70, s4, 8
    s_add_u32 s76, s76, s70
    s_lshl_b32 s70, s77, 1
    s_add_u32 s76, s76, s70
    s_add_u32 s76, s76, 1048576
    v_and_b32 v14, 15, v0
    v_lshlrev_b32_e64 v14, 12, v14
    v_lshl_add_u32 v14, v15, 4, v14
    ds_read_b128 v[40:43], v13 offset:0
    ds_read_b128 v[44:47], v13 offset:16
    ds_read_b128 v[48:51], v13 offset:32
    ds_read_b128 v[52:55], v13 offset:48
    ds_read_b128 v[56:59], v13 offset:256
    ds_read_b128 v[60:63], v13 offset:272
    ds_read_b128 v[64:67], v13 offset:288
    ds_read_b128 v[68:71], v13 offset:304
    s_waitcnt lgkmcnt(0)
    v_lshlrev_b32 v16, 16, v84
    v_and_b32 v17, 0xffff0000, v84
    v_sub_f32 v16, v16, v40
    v_sub_f32 v17, v17, v42
    v_cvt_pk_bf16_f32 v84, v16, v17
    v_lshlrev_b32 v16, 16, v84
    v_and_b32 v17, 0xffff0000, v84
    v_mul_f32 v16, v16, v41
    v_mul_f32 v17, v17, v43
    v_cvt_pk_bf16_f32 v84, v16, v17
    v_lshlrev_b32 v18, 16, v85
    v_and_b32 v19, 0xffff0000, v85
    v_sub_f32 v18, v18, v44
    v_sub_f32 v19, v19, v46
    v_cvt_pk_bf16_f32 v85, v18, v19
    v_lshlrev_b32 v18, 16, v85
    v_and_b32 v19, 0xffff0000, v85
    v_mul_f32 v18, v18, v45
    v_mul_f32 v19, v19, v47
    v_cvt_pk_bf16_f32 v85, v18, v19
    v_lshlrev_b32 v16, 16, v86
    v_and_b32 v17, 0xffff0000, v86
    v_sub_f32 v16, v16, v48
    v_sub_f32 v17, v17, v50
    v_cvt_pk_bf16_f32 v86, v16, v17
    v_lshlrev_b32 v16, 16, v86
    v_and_b32 v17, 0xffff0000, v86
    v_mul_f32 v16, v16, v49
    v_mul_f32 v17, v17, v51
    v_cvt_pk_bf16_f32 v86, v16, v17
    v_lshlrev_b32 v18, 16, v87
    v_and_b32 v19, 0xffff0000, v87
    v_sub_f32 v18, v18, v52
    v_sub_f32 v19, v19, v54
    v_cvt_pk_bf16_f32 v87, v18, v19
    v_lshlrev_b32 v18, 16, v87
    v_and_b32 v19, 0xffff0000, v87
    v_mul_f32 v18, v18, v53
    v_mul_f32 v19, v19, v55
    v_cvt_pk_bf16_f32 v87, v18, v19
    s_add_u32 s70, s76, 0
    buffer_store_dwordx4 v[84:87], v14, s[16:19], s70 offen offset:0 sc1
    v_lshlrev_b32 v16, 16, v88
    v_and_b32 v17, 0xffff0000, v88
    v_sub_f32 v16, v16, v40
    v_sub_f32 v17, v17, v42
    v_cvt_pk_bf16_f32 v88, v16, v17
    v_lshlrev_b32 v16, 16, v88
    v_and_b32 v17, 0xffff0000, v88
    v_mul_f32 v16, v16, v41
    v_mul_f32 v17, v17, v43
    v_cvt_pk_bf16_f32 v88, v16, v17
    v_lshlrev_b32 v18, 16, v89
    v_and_b32 v19, 0xffff0000, v89
    v_sub_f32 v18, v18, v44
    v_sub_f32 v19, v19, v46
    v_cvt_pk_bf16_f32 v89, v18, v19
    v_lshlrev_b32 v18, 16, v89
    v_and_b32 v19, 0xffff0000, v89
    v_mul_f32 v18, v18, v45
    v_mul_f32 v19, v19, v47
    v_cvt_pk_bf16_f32 v89, v18, v19
    v_lshlrev_b32 v16, 16, v90
    v_and_b32 v17, 0xffff0000, v90
    v_sub_f32 v16, v16, v48
    v_sub_f32 v17, v17, v50
    v_cvt_pk_bf16_f32 v90, v16, v17
    v_lshlrev_b32 v16, 16, v90
    v_and_b32 v17, 0xffff0000, v90
    v_mul_f32 v16, v16, v49
    v_mul_f32 v17, v17, v51
    v_cvt_pk_bf16_f32 v90, v16, v17
    v_lshlrev_b32 v18, 16, v91
    v_and_b32 v19, 0xffff0000, v91
    v_sub_f32 v18, v18, v52
    v_sub_f32 v19, v19, v54
    v_cvt_pk_bf16_f32 v91, v18, v19
    v_lshlrev_b32 v18, 16, v91
    v_and_b32 v19, 0xffff0000, v91
    v_mul_f32 v18, v18, v53
    v_mul_f32 v19, v19, v55
    v_cvt_pk_bf16_f32 v91, v18, v19
    s_add_u32 s70, s76, 65536
    buffer_store_dwordx4 v[88:91], v14, s[16:19], s70 offen offset:0 sc1
    v_lshlrev_b32 v16, 16, v92
    v_and_b32 v17, 0xffff0000, v92
    v_sub_f32 v16, v16, v40
    v_sub_f32 v17, v17, v42
    v_cvt_pk_bf16_f32 v92, v16, v17
    v_lshlrev_b32 v16, 16, v92
    v_and_b32 v17, 0xffff0000, v92
    v_mul_f32 v16, v16, v41
    v_mul_f32 v17, v17, v43
    v_cvt_pk_bf16_f32 v92, v16, v17
    v_lshlrev_b32 v18, 16, v93
    v_and_b32 v19, 0xffff0000, v93
    v_sub_f32 v18, v18, v44
    v_sub_f32 v19, v19, v46
    v_cvt_pk_bf16_f32 v93, v18, v19
    v_lshlrev_b32 v18, 16, v93
    v_and_b32 v19, 0xffff0000, v93
    v_mul_f32 v18, v18, v45
    v_mul_f32 v19, v19, v47
    v_cvt_pk_bf16_f32 v93, v18, v19
    v_lshlrev_b32 v16, 16, v94
    v_and_b32 v17, 0xffff0000, v94
    v_sub_f32 v16, v16, v48
    v_sub_f32 v17, v17, v50
    v_cvt_pk_bf16_f32 v94, v16, v17
    v_lshlrev_b32 v16, 16, v94
    v_and_b32 v17, 0xffff0000, v94
    v_mul_f32 v16, v16, v49
    v_mul_f32 v17, v17, v51
    v_cvt_pk_bf16_f32 v94, v16, v17
    v_lshlrev_b32 v18, 16, v95
    v_and_b32 v19, 0xffff0000, v95
    v_sub_f32 v18, v18, v52
    v_sub_f32 v19, v19, v54
    v_cvt_pk_bf16_f32 v95, v18, v19
    v_lshlrev_b32 v18, 16, v95
    v_and_b32 v19, 0xffff0000, v95
    v_mul_f32 v18, v18, v53
    v_mul_f32 v19, v19, v55
    v_cvt_pk_bf16_f32 v95, v18, v19
    s_add_u32 s70, s76, 131072
    buffer_store_dwordx4 v[92:95], v14, s[16:19], s70 offen offset:0 sc1
    v_lshlrev_b32 v16, 16, v96
    v_and_b32 v17, 0xffff0000, v96
    v_sub_f32 v16, v16, v40
    v_sub_f32 v17, v17, v42
    v_cvt_pk_bf16_f32 v96, v16, v17
    v_lshlrev_b32 v16, 16, v96
    v_and_b32 v17, 0xffff0000, v96
    v_mul_f32 v16, v16, v41
    v_mul_f32 v17, v17, v43
    v_cvt_pk_bf16_f32 v96, v16, v17
    v_lshlrev_b32 v18, 16, v97
    v_and_b32 v19, 0xffff0000, v97
    v_sub_f32 v18, v18, v44
    v_sub_f32 v19, v19, v46
    v_cvt_pk_bf16_f32 v97, v18, v19
    v_lshlrev_b32 v18, 16, v97
    v_and_b32 v19, 0xffff0000, v97
    v_mul_f32 v18, v18, v45
    v_mul_f32 v19, v19, v47
    v_cvt_pk_bf16_f32 v97, v18, v19
    v_lshlrev_b32 v16, 16, v98
    v_and_b32 v17, 0xffff0000, v98
    v_sub_f32 v16, v16, v48
    v_sub_f32 v17, v17, v50
    v_cvt_pk_bf16_f32 v98, v16, v17
    v_lshlrev_b32 v16, 16, v98
    v_and_b32 v17, 0xffff0000, v98
    v_mul_f32 v16, v16, v49
    v_mul_f32 v17, v17, v51
    v_cvt_pk_bf16_f32 v98, v16, v17
    v_lshlrev_b32 v18, 16, v99
    v_and_b32 v19, 0xffff0000, v99
    v_sub_f32 v18, v18, v52
    v_sub_f32 v19, v19, v54
    v_cvt_pk_bf16_f32 v99, v18, v19
    v_lshlrev_b32 v18, 16, v99
    v_and_b32 v19, 0xffff0000, v99
    v_mul_f32 v18, v18, v53
    v_mul_f32 v19, v19, v55
    v_cvt_pk_bf16_f32 v99, v18, v19
    s_add_u32 s70, s76, 196608
    buffer_store_dwordx4 v[96:99], v14, s[16:19], s70 offen offset:0 sc1
    s_cmp_eq_u32 s78, 0
    s_cbranch_scc1 L1noxnt
    v_lshlrev_b32 v16, 16, v100
    v_and_b32 v17, 0xffff0000, v100
    v_sub_f32 v16, v16, v56
    v_sub_f32 v17, v17, v58
    v_cvt_pk_bf16_f32 v100, v16, v17
    v_lshlrev_b32 v16, 16, v100
    v_and_b32 v17, 0xffff0000, v100
    v_mul_f32 v16, v16, v57
    v_mul_f32 v17, v17, v59
    v_cvt_pk_bf16_f32 v100, v16, v17
    v_lshlrev_b32 v18, 16, v101
    v_and_b32 v19, 0xffff0000, v101
    v_sub_f32 v18, v18, v60
    v_sub_f32 v19, v19, v62
    v_cvt_pk_bf16_f32 v101, v18, v19
    v_lshlrev_b32 v18, 16, v101
    v_and_b32 v19, 0xffff0000, v101
    v_mul_f32 v18, v18, v61
    v_mul_f32 v19, v19, v63
    v_cvt_pk_bf16_f32 v101, v18, v19
    v_lshlrev_b32 v16, 16, v102
    v_and_b32 v17, 0xffff0000, v102
    v_sub_f32 v16, v16, v64
    v_sub_f32 v17, v17, v66
    v_cvt_pk_bf16_f32 v102, v16, v17
    v_lshlrev_b32 v16, 16, v102
    v_and_b32 v17, 0xffff0000, v102
    v_mul_f32 v16, v16, v65
    v_mul_f32 v17, v17, v67
    v_cvt_pk_bf16_f32 v102, v16, v17
    v_lshlrev_b32 v18, 16, v103
    v_and_b32 v19, 0xffff0000, v103
    v_sub_f32 v18, v18, v68
    v_sub_f32 v19, v19, v70
    v_cvt_pk_bf16_f32 v103, v18, v19
    v_lshlrev_b32 v18, 16, v103
    v_and_b32 v19, 0xffff0000, v103
    v_mul_f32 v18, v18, v69
    v_mul_f32 v19, v19, v71
    v_cvt_pk_bf16_f32 v103, v18, v19
    s_add_u32 s70, s76, 0
    buffer_store_dwordx4 v[100:103], v14, s[16:19], s70 offen offset:64 sc1
    v_lshlrev_b32 v16, 16, v104
    v_and_b32 v17, 0xffff0000, v104
    v_sub_f32 v16, v16, v56
    v_sub_f32 v17, v17, v58
    v_cvt_pk_bf16_f32 v104, v16, v17
    v_lshlrev_b32 v16, 16, v104
    v_and_b32 v17, 0xffff0000, v104
    v_mul_f32 v16, v16, v57
    v_mul_f32 v17, v17, v59
    v_cvt_pk_bf16_f32 v104, v16, v17
    v_lshlrev_b32 v18, 16, v105
    v_and_b32 v19, 0xffff0000, v105
    v_sub_f32 v18, v18, v60
    v_sub_f32 v19, v19, v62
    v_cvt_pk_bf16_f32 v105, v18, v19
    v_lshlrev_b32 v18, 16, v105
    v_and_b32 v19, 0xffff0000, v105
    v_mul_f32 v18, v18, v61
    v_mul_f32 v19, v19, v63
    v_cvt_pk_bf16_f32 v105, v18, v19
    v_lshlrev_b32 v16, 16, v106
    v_and_b32 v17, 0xffff0000, v106
    v_sub_f32 v16, v16, v64
    v_sub_f32 v17, v17, v66
    v_cvt_pk_bf16_f32 v106, v16, v17
    v_lshlrev_b32 v16, 16, v106
    v_and_b32 v17, 0xffff0000, v106
    v_mul_f32 v16, v16, v65
    v_mul_f32 v17, v17, v67
    v_cvt_pk_bf16_f32 v106, v16, v17
    v_lshlrev_b32 v18, 16, v107
    v_and_b32 v19, 0xffff0000, v107
    v_sub_f32 v18, v18, v68
    v_sub_f32 v19, v19, v70
    v_cvt_pk_bf16_f32 v107, v18, v19
    v_lshlrev_b32 v18, 16, v107
    v_and_b32 v19, 0xffff0000, v107
    v_mul_f32 v18, v18, v69
    v_mul_f32_e64 v19, v19, v71
    v_cvt_pk_bf16_f32 v107, v18, v19
    s_add_u32 s70, s76, 65536
    buffer_store_dwordx4 v[104:107], v14, s[16:19], s70 offen offset:64 sc1
    v_lshlrev_b32 v16, 16, v108
    v_and_b32 v17, 0xffff0000, v108
    v_sub_f32 v16, v16, v56
    v_sub_f32 v17, v17, v58
    v_cvt_pk_bf16_f32 v108, v16, v17
    v_lshlrev_b32 v16, 16, v108
    v_and_b32 v17, 0xffff0000, v108
    v_mul_f32 v16, v16, v57
    v_mul_f32 v17, v17, v59
    v_cvt_pk_bf16_f32 v108, v16, v17
    v_lshlrev_b32 v18, 16, v109
    v_and_b32 v19, 0xffff0000, v109
    v_sub_f32 v18, v18, v60
    v_sub_f32 v19, v19, v62
    v_cvt_pk_bf16_f32 v109, v18, v19
    v_lshlrev_b32 v18, 16, v109
    v_and_b32 v19, 0xffff0000, v109
    v_mul_f32 v18, v18, v61
    v_mul_f32 v19, v19, v63
    v_cvt_pk_bf16_f32 v109, v18, v19
    v_lshlrev_b32 v16, 16, v110
    v_and_b32 v17, 0xffff0000, v110
    v_sub_f32 v16, v16, v64
    v_sub_f32 v17, v17, v66
    v_cvt_pk_bf16_f32 v110, v16, v17
    v_lshlrev_b32 v16, 16, v110
    v_and_b32 v17, 0xffff0000, v110
    v_mul_f32 v16, v16, v65
    v_mul_f32 v17, v17, v67
    v_cvt_pk_bf16_f32 v110, v16, v17
    v_lshlrev_b32 v18, 16, v111
    v_and_b32 v19, 0xffff0000, v111
    v_sub_f32 v18, v18, v68
    v_sub_f32 v19, v19, v70
    v_cvt_pk_bf16_f32 v111, v18, v19
    v_lshlrev_b32 v18, 16, v111
    v_and_b32 v19, 0xffff0000, v111
    v_mul_f32 v18, v18, v69
    v_mul_f32 v19, v19, v71
    v_cvt_pk_bf16_f32 v111, v18, v19
    s_add_u32 s70, s76, 131072
    buffer_store_dwordx4 v[108:111], v14, s[16:19], s70 offen offset:64 sc1
    v_lshlrev_b32 v16, 16, v112
    v_and_b32 v17, 0xffff0000, v112
    v_sub_f32 v16, v16, v56
    v_sub_f32 v17, v17, v58
    v_cvt_pk_bf16_f32 v112, v16, v17
    v_lshlrev_b32 v16, 16, v112
    v_and_b32 v17, 0xffff0000, v112
    v_mul_f32 v16, v16, v57
    v_mul_f32 v17, v17, v59
    v_cvt_pk_bf16_f32 v112, v16, v17
    v_lshlrev_b32 v18, 16, v113
    v_and_b32 v19, 0xffff0000, v113
    v_sub_f32 v18, v18, v60
    v_sub_f32 v19, v19, v62
    v_cvt_pk_bf16_f32 v113, v18, v19
    v_lshlrev_b32 v18, 16, v113
    v_and_b32 v19, 0xffff0000, v113
    v_mul_f32 v18, v18, v61
    v_mul_f32 v19, v19, v63
    v_cvt_pk_bf16_f32 v113, v18, v19
    v_lshlrev_b32 v16, 16, v114
    v_and_b32 v17, 0xffff0000, v114
    v_sub_f32 v16, v16, v64
    v_sub_f32 v17, v17, v66
    v_cvt_pk_bf16_f32 v114, v16, v17
    v_lshlrev_b32 v16, 16, v114
    v_and_b32 v17, 0xffff0000, v114
    v_mul_f32 v16, v16, v65
    v_mul_f32 v17, v17, v67
    v_cvt_pk_bf16_f32 v114, v16, v17
    v_lshlrev_b32 v18, 16, v115
    v_and_b32 v19, 0xffff0000, v115
    v_sub_f32 v18, v18, v68
    v_sub_f32 v19, v19, v70
    v_cvt_pk_bf16_f32 v115, v18, v19
    v_lshlrev_b32 v18, 16, v115
    v_and_b32 v19, 0xffff0000, v115
    v_mul_f32 v18, v18, v69
    v_mul_f32 v19, v19, v71
    v_cvt_pk_bf16_f32 v115, v18, v19
    s_add_u32 s70, s76, 196608
    buffer_store_dwordx4 v[112:115], v14, s[16:19], s70 offen offset:64 sc1
L1noxnt:
    s_endpgm
L1kg:
    s_sub_u32 s3, s3, 9
    s_add_u32 s69, s3, s60
    s_cmp_ge_u32 s69, 3
    s_cbranch_scc1 L1end
    s_setprio 3
    s_lshr_b32 s70, s2, 1
    s_mul_i32 s70, s70, 5
    s_mul_i32 s71, s60, 3
    s_add_u32 s70, s70, s71
    s_add_u32 s70, s70, s3
    s_nop 0
    s_mul_i32 s71, s70, 384
    v_lshl_add_u32 v16, v0, 2, s71
    v_lshl_add_u32 v18, v0, 1, s71
    s_lshl_b32 s72, s70, 1
    v_mov_b32 v17, s72
    s_waitcnt lgkmcnt(0)
    s_nop 0
    global_load_dword v64, v16, s[34:35]
    global_load_ushort v65, v18, s[34:35] offset:256
    global_load_dword v66, v16, s[36:37]
    global_load_ushort v67, v18, s[36:37] offset:256
    global_load_dword v68, v16, s[38:39]
    global_load_ushort v69, v18, s[38:39] offset:256
    global_load_dword v70, v16, s[40:41]
    global_load_ushort v71, v18, s[40:41] offset:256
    global_load_ushort v13, v17, s[42:43]
    global_load_ushort v14, v17, s[44:45]
    s_setprio 0
    s_mov_b32 s16, s58
    s_mov_b32 s17, s59
    s_nop 0
    s_mov_b32 s18, 268435456
    s_mov_b32 s19, 0x20000
    s_mov_b32 s72, 1069066811
    s_mov_b32 s73, 849703008
    s_mov_b32 s74, 1060205080
    s_mul_i32 s75, s3, 6800
    s_add_u32 s75, s75, 123264
    s_lshl_b32 s76, s70, 11
    s_nop 0
    s_add_u32 s76, s76, 4194304
    s_mov_b32 s77, 272
    v_lshl_add_u32 v80, v0, 2, s75
    v_and_b32 v81, 15, v0
    v_lshrrev_b32 v82, 4, v0
    v_lshl_add_u32 v82, v82, 4, s75
    v_mov_b32 v164, 0x3c00
    ds_write_b32 v80, v164
    v_and_b32 v84, 3, v81
    v_lshrrev_b32 v85, 2, v81
    v_and_b32 v86, 7, v81
    v_lshrrev_b32 v87, 3, v81
    v_mad_u32_u24 v156, v84, s77, v82
    v_add_u32 v88, 4, v85
    v_mad_u32_u24 v157, v88, s77, v82
    v_add_u32 v88, 16, v87
    v_mad_u32_u24 v158, v88, s77, v82
    v_add_u32 v88, 8, v86
    v_mad_u32_u24 v159, v88, s77, v82
    v_cmp_lt_u32 vcc, 7, v81
    v_add_u32 v88, 18, v85
    v_lshrrev_b32 v89, 1, v86
    v_add_u32 v89, 16, v89
    v_cndmask_b32 v88, v88, v89, vcc
    v_mad_u32_u24 v160, v88, s77, v82
    v_lshl_add_u32 v88, v84, 1, 8
    v_and_b32 v89, 1, v81
    v_add_u32 v89, 20, v89
    v_cndmask_b32 v88, v88, v89, vcc
    v_mad_u32_u24 v161, v88, s77, v82
    v_add_u32 v88, 16, v84
    v_mad_u32_u24 v162, v88, s77, v82
    v_min_u32 v88, 2, v85
    v_add_u32 v88, 22, v88
    v_mad_u32_u24 v163, v88, s77, v82
    v_add_u32 v150, 272, v80
    v_add_u32 v151, 1360, v80
    v_add_u32 v152, 2448, v80
    v_add_u32 v153, 3536, v80
    v_add_u32 v154, 4624, v80
    v_add_u32 v155, 5712, v80
    s_waitcnt vmcnt(0)
    v_lshlrev_b32 v1, 16, v64
    v_and_b32 v5, 0xffff0000, v64
    v_lshlrev_b32 v9, 16, v65
    v_lshlrev_b32 v2, 16, v66
    v_and_b32 v6, 0xffff0000, v66
    v_lshlrev_b32 v10, 16, v67
    v_lshlrev_b32 v3, 16, v68
    v_and_b32 v7, 0xffff0000, v68
    v_lshlrev_b32 v11, 16, v69
    v_lshlrev_b32 v4, 16, v70
    v_and_b32 v8, 0xffff0000, v70
    v_lshlrev_b32 v12, 16, v71
    v_lshlrev_b32 v13, 16, v13
    v_lshlrev_b32 v14, 16, v14
    v_mul_f32 v72, s72, v13
    v_fma_f32 v73, v13, s72, -v72
    v_fma_f32 v73, v13, s73, v73
    v_exp_f32 v72, v72
    v_mul_f32 v73, s74, v73
    v_fma_f32 v72, v72, v73, v72
    v_cvt_pk_bf16_f32 v72, v72, v72
    v_lshlrev_b32_e64 v13, 16, v72
    v_max3_f32 v74, abs(v3), abs(v4), abs(v7)
    v_max3_f32 v74, abs(v8), abs(v11), v74
    v_max_f32 v74, abs(v12), v74
    s_nop 1
    v_max_f32_dpp v74, v74, v74 quad_perm:[1,0,3,2] row_mask:0xf bank_mask:0xf
    s_nop 1
    v_max_f32_dpp v74, v74, v74 quad_perm:[2,3,0,1] row_mask:0xf bank_mask:0xf
    s_nop 1
    v_max_f32_dpp v74, v74, v74 row_half_mirror row_mask:0xf bank_mask:0xf
    s_nop 1
    v_max_f32_dpp v74, v74, v74 row_mirror row_mask:0xf bank_mask:0xf
    v_mov_b32 v75, v74
    s_nop 1
    v_permlane16_swap_b32 v74, v75
    v_max_f32 v74, v74, v75
    v_mov_b32 v75, v74
    s_nop 1
    v_permlane32_swap_b32 v74, v75
    v_max_f32 v74, v74, v75
    v_frexp_exp_i32_f32 v74, v74
    v_sub_u32 v75, 8, v74
    v_subrev_u32 v74, 7, v74
    v_ldexp_f32 v15, v13, v74
    v_mul_f32 v76, s72, v1
    v_fma_f32 v77, v1, s72, -v76
    v_fma_f32 v77, v1, s73, v77
    v_exp_f32 v76, v76
    v_mul_f32 v77, s74, v77
    v_fma_f32 v76, v76, v77, v76
    v_cvt_pk_bf16_f32 v76, v76, v76
    v_lshlrev_b32 v1, 16, v76
    v_mul_f32 v1, v1, v13
    v_mul_f32 v2, v2, v13
    v_mul_f32 v1, 0xbfb8aa3b, v1
    v_mul_f32 v2, 0.15915494, v2
    v_ldexp_f32 v3, v3, v75
    v_ldexp_f32 v4, v4, v75
    v_mul_f32 v76, s72, v5
    v_fma_f32 v77, v5, s72, -v76
    v_fma_f32 v77, v5, s73, v77
    v_exp_f32 v76, v76
    v_mul_f32 v77, s74, v77
    v_fma_f32 v76, v76, v77, v76
    v_cvt_pk_bf16_f32 v76, v76, v76
    v_lshlrev_b32 v5, 16, v76
    v_mul_f32 v5, v5, v13
    v_mul_f32 v6, v6, v13
    v_mul_f32 v5, 0xbfb8aa3b, v5
    v_mul_f32 v6, 0.15915494, v6
    v_ldexp_f32 v7, v7, v75
    v_ldexp_f32 v8, v8, v75
    v_mul_f32 v76, s72, v9
    v_fma_f32 v77, v9, s72, -v76
    v_fma_f32 v77, v9, s73, v77
    v_exp_f32 v76, v76
    v_mul_f32 v77, s74, v77
    v_fma_f32 v76, v76, v77, v76
    v_cvt_pk_bf16_f32 v76, v76, v76
    v_lshlrev_b32 v9, 16, v76
    v_mul_f32 v9, v9, v13
    v_mul_f32 v10, v10, v13
    v_mul_f32 v9, 0xbfb8aa3b, v9
    v_mul_f32 v10, 0.15915494, v10
    v_ldexp_f32 v11, v11, v75
    v_ldexp_f32 v12, v12, v75
    v_exp_f32 v40, v1
    v_fract_f32 v41, v2
    v_mul_f32 v42, 16.0, v1
    v_cos_f32 v28, v41
    v_sin_f32 v29, v41
    v_mul_f32 v43, 16.0, v2
    v_mul_f32 v28, v28, v40
    v_mul_f32 v29, v29, v40
    v_exp_f32 v42, v42
    v_fract_f32 v43, v43
    v_mul_f32 v44, 256.0, v1
    v_cos_f32 v32, v43
    v_sin_f32 v33, v43
    v_mul_f32 v45, 256.0, v2
    v_mul_f32 v32, v32, v42
    v_mul_f32 v33, v33, v42
    v_exp_f32 v44, v44
    v_fract_f32 v45, v45
    v_cvt_pk_f16_f32 v59, v3, v4
    v_cos_f32 v36, v45
    v_sin_f32 v37, v45
    v_cvt_pk_f16_f32 v52, v28, v29
    v_mul_f32 v36, v36, v44
    v_mul_f32 v37, v37, v44
    v_cvt_pk_f16_f32 v47, v32, -v33
    v_cvt_pk_f16_f32 v137, v36, v37
    v_mul_f32 v30, v28, v28
    v_mul_f32 v31, v28, v29
    v_fma_f32 v30, -v29, v29, v30
    v_add_f32 v31, v31, v31
    v_mul_f32 v34, v32, v32
    v_mul_f32 v35, v32, v33
    v_fma_f32 v34, -v33, v33, v34
    v_add_f32 v35, v35, v35
    v_mul_f32 v38, v36, v36
    v_mul_f32 v39, v36, v37
    v_fma_f32 v38, -v37, v37, v38
    v_add_f32_e64 v39, v39, v39
    v_cvt_pk_f16_f32 v53, v30, v31
    v_cvt_pk_f16_f32 v49, v34, -v35
    v_cvt_pk_f16_f32 v63, v38, v39
    v_mul_f32 v28, v30, v30
    v_mul_f32 v29, v30, v31
    v_fma_f32 v28, -v31, v31, v28
    v_add_f32 v29, v29, v29
    v_mul_f32 v32, v34, v34
    v_mul_f32 v33, v34, v35
    v_fma_f32 v32, -v35, v35, v32
    v_add_f32 v33, v33, v33
    v_mul_f32 v36, v38, v38
    v_mul_f32 v37, v38, v39
    v_fma_f32 v36, -v39, v39, v36
    v_add_f32_e64 v37, v37, v37
    v_cvt_pk_f16_f32 v55, v28, v29
    v_cvt_pk_f16_f32 v50, v32, -v33
    v_cvt_pk_f16_f32 v133, v36, v37
    v_mul_f32 v30, v28, v28
    v_mul_f32 v31, v28, v29
    v_fma_f32 v30, -v29, v29, v30
    v_add_f32 v31, v31, v31
    v_mul_f32 v34, v32, v32
    v_mul_f32 v35, v32, v33
    v_fma_f32 v34, -v33, v33, v34
    v_add_f32 v35, v35, v35
    v_mul_f32 v38, v36, v36
    v_mul_f32 v39, v36, v37
    v_fma_f32 v38, -v37, v37, v38
    v_add_f32_e64 v39, v39, v39
    v_cvt_pk_f16_f32 v46, v30, -v31
    v_cvt_pk_f16_f32 v136, v34, v35
    v_cvt_pk_f16_f32 v135, v38, v39
    v_pk_mul_f16 v138, v59, v137 op_sel:[0,0] op_sel_hi:[0,1]
    v_pk_mul_f16 v139, v52, v53 op_sel:[0,0] op_sel_hi:[0,1]
    v_pk_fma_f16 v61, v59, v137, v138 op_sel:[1,1,0] op_sel_hi:[1,0,1] neg_lo:[0,1,0]
    v_pk_fma_f16 v54, v52, v53, v139 op_sel:[1,1,0] op_sel_hi:[1,0,1] neg_lo:[0,1,0]
    v_pk_mul_f16 v140, v55, v52 op_sel:[0,0] op_sel_hi:[0,1]
    v_pk_mul_f16 v141, v55, v53 op_sel:[0,0] op_sel_hi:[0,1]
    v_pk_fma_f16 v56, v55, v52, v140 op_sel:[1,1,0] op_sel_hi:[1,0,1] neg_lo:[0,1,0]
    v_pk_fma_f16 v57, v55, v53, v141 op_sel:[1,1,0] op_sel_hi:[1,0,1] neg_lo:[0,1,0]
    v_pk_mul_f16 v138, v55, v54 op_sel:[0,0] op_sel_hi:[0,1]
    v_pk_mul_f16 v139, v49, v50 op_sel:[0,0] op_sel_hi:[0,1]
    v_pk_fma_f16 v58, v55, v54, v138 op_sel:[1,1,0] op_sel_hi:[1,0,1] neg_lo:[0,1,0]
    v_pk_fma_f16 v51, v49, v50, v139 op_sel:[1,1,0] op_sel_hi:[1,0,1] neg_lo:[0,1,0]
    v_pk_mul_f16 v140, v63, v55 op_sel:[0,0] op_sel_hi:[0,1]
    v_pk_mul_f16 v141, v63, v133 op_sel:[0,0] op_sel_hi:[0,1]
    v_pk_fma_f16 v132, v63, v55, v140 op_sel:[1,1,0] op_sel_hi:[1,0,1] neg_lo:[0,1,0]
    v_pk_fma_f16 v134, v63, v133, v141 op_sel:[1,1,0] op_sel_hi:[1,0,1] neg_lo:[0,1,0]
    v_pk_mul_f16 v138, v46, v47 op_sel:[0,0] op_sel_hi:[0,1]
    v_pk_mul_f16 v139, v59, v136 op_sel:[0,0] op_sel_hi:[0,1]
    v_pk_fma_f16 v48, v46, v47, v138 op_sel:[1,1,0] op_sel_hi:[1,0,1] neg_lo:[0,1,0]
    v_pk_fma_f16 v60, v59, v136, v139 op_sel:[1,1,0] op_sel_hi:[1,0,1] neg_lo:[0,1,0]
    v_pk_mul_f16 v140, v61, v136 op_sel:[0,0] op_sel_hi:[0,1]
    v_pk_fma_f16 v62, v61, v136, v140 op_sel:[1,1,0] op_sel_hi:[1,0,1] neg_lo:[0,1,0]
    ds_write2_b32 v150, v46, v47 offset0:0 offset1:68
    ds_write2_b32 v150, v48, v164 offset0:136 offset1:204
    ds_write2_b32 v151, v49, v50 offset0:0 offset1:68
    ds_write2_b32 v151, v51, v164 offset0:136 offset1:204
    ds_write2_b32 v152, v52, v53 offset0:0 offset1:68
    ds_write2_b32 v152, v54, v55 offset0:136 offset1:204
    ds_write2_b32 v153, v56, v57 offset0:0 offset1:68
    ds_write2_b32 v153, v58, v59 offset0:136 offset1:204
    ds_write2_b32 v154, v60, v61 offset0:0 offset1:68
    ds_write2_b32 v154, v62, v63 offset0:136 offset1:204
    ds_write2_b32 v155, v132, v133 offset0:0 offset1:68
    ds_write2_b32 v155, v134, v135 offset0:136 offset1:204
    ds_read_b128 v[64:67], v156 offset:0
    ds_read_b128 v[68:71], v157 offset:0
    ds_read_b128 v[72:75], v158 offset:0
    ds_read_b128 v[76:79], v159 offset:0
    ds_read_b128 v[80:83], v160 offset:0
    ds_read_b128 v[84:87], v161 offset:0
    ds_read_b128 v[88:91], v162 offset:0
    ds_read_b128 v[92:95], v163 offset:0
    ds_read_b128 v[96:99], v156 offset:64
    ds_read_b128 v[100:103], v157 offset:64
    ds_read_b128 v[104:107], v158 offset:64
    ds_read_b128 v[108:111], v159 offset:64
    ds_read_b128 v[112:115], v160 offset:64
    ds_read_b128 v[116:119], v161 offset:64
    ds_read_b128 v[120:123], v162 offset:64
    ds_read_b128 v[124:127], v163 offset:64
    v_exp_f32 v40, v5
    v_fract_f32 v41, v6
    v_mul_f32 v42, 16.0, v5
    v_cos_f32 v28, v41
    v_sin_f32 v29, v41
    v_mul_f32 v43, 16.0, v6
    v_mul_f32 v28, v28, v40
    v_mul_f32 v29, v29, v40
    v_exp_f32 v42, v42
    v_fract_f32 v43, v43
    v_mul_f32 v44, 256.0, v5
    v_cos_f32 v32, v43
    v_sin_f32 v33, v43
    v_mul_f32 v45, 256.0, v6
    v_mul_f32 v32, v32, v42
    v_mul_f32 v33, v33, v42
    v_exp_f32 v44, v44
    v_fract_f32 v45, v45
    v_cvt_pk_f16_f32 v59, v7, v8
    v_cos_f32 v36, v45
    v_sin_f32 v37, v45
    v_cvt_pk_f16_f32 v52, v28, v29
    v_mul_f32 v36, v36, v44
    v_mul_f32 v37, v37, v44
    v_cvt_pk_f16_f32 v47, v32, -v33
    v_cvt_pk_f16_f32 v137, v36, v37
    v_mul_f32 v30, v28, v28
    v_mul_f32 v31, v28, v29
    v_fma_f32 v30, -v29, v29, v30
    v_add_f32 v31, v31, v31
    v_mul_f32 v34, v32, v32
    v_mul_f32 v35, v32, v33
    v_fma_f32 v34, -v33, v33, v34
    v_add_f32 v35, v35, v35
    v_mul_f32 v38, v36, v36
    v_mul_f32 v39, v36, v37
    v_fma_f32 v38, -v37, v37, v38
    v_add_f32_e64 v39, v39, v39
    v_cvt_pk_f16_f32 v53, v30, v31
    v_cvt_pk_f16_f32 v49, v34, -v35
    v_cvt_pk_f16_f32 v63, v38, v39
    s_waitcnt lgkmcnt(8)
    s_nop 0
    v_pk_mul_f16 v128, v64, v68 op_sel:[0,0] op_sel_hi:[0,1]
    v_pk_mul_f16 v129, v65, v69 op_sel:[0,0] op_sel_hi:[0,1]
    v_pk_fma_f16 v64, v64, v68, v128 op_sel:[1,1,0] op_sel_hi:[1,0,1] neg_lo:[0,1,0]
    v_pk_fma_f16 v65, v65, v69, v129 op_sel:[1,1,0] op_sel_hi:[1,0,1] neg_lo:[0,1,0]
    v_pk_mul_f16 v130, v66, v70 op_sel:[0,0] op_sel_hi:[0,1]
    v_pk_mul_f16 v131, v67, v71 op_sel:[0,0] op_sel_hi:[0,1]
    v_pk_fma_f16 v66, v66, v70, v130 op_sel:[1,1,0] op_sel_hi:[1,0,1] neg_lo:[0,1,0]
    v_pk_fma_f16 v67, v67, v71, v131 op_sel:[1,1,0] op_sel_hi:[1,0,1] neg_lo:[0,1,0]
    v_pk_mul_f16 v128, v72, v76 op_sel:[0,0] op_sel_hi:[0,1]
    v_pk_mul_f16 v129, v73, v77 op_sel:[0,0] op_sel_hi:[0,1]
    v_pk_fma_f16 v72, v72, v76, v128 op_sel:[1,1,0] op_sel_hi:[1,0,1] neg_lo:[0,1,0]
    v_pk_fma_f16 v73, v73, v77, v129 op_sel:[1,1,0] op_sel_hi:[1,0,1] neg_lo:[0,1,0]
    v_pk_mul_f16 v130, v74, v78 op_sel:[0,0] op_sel_hi:[0,1]
    v_pk_mul_f16 v131, v75, v79 op_sel:[0,0] op_sel_hi:[0,1]
    v_pk_fma_f16 v74, v74, v78, v130 op_sel:[1,1,0] op_sel_hi:[1,0,1] neg_lo:[0,1,0]
    v_pk_fma_f16 v75, v75, v79, v131 op_sel:[1,1,0] op_sel_hi:[1,0,1] neg_lo:[0,1,0]
    v_pk_mul_f16 v128, v80, v84 op_sel:[0,0] op_sel_hi:[0,1]
    v_pk_mul_f16 v129, v81, v85 op_sel:[0,0] op_sel_hi:[0,1]
    v_pk_fma_f16 v80, v80, v84, v128 op_sel:[1,1,0] op_sel_hi:[1,0,1] neg_lo:[0,1,0]
    v_pk_fma_f16 v81, v81, v85, v129 op_sel:[1,1,0] op_sel_hi:[1,0,1] neg_lo:[0,1,0]
    v_pk_mul_f16 v130, v82, v86 op_sel:[0,0] op_sel_hi:[0,1]
    v_pk_mul_f16 v131, v83, v87 op_sel:[0,0] op_sel_hi:[0,1]
    v_pk_fma_f16 v82, v82, v86, v130 op_sel:[1,1,0] op_sel_hi:[1,0,1] neg_lo:[0,1,0]
    v_pk_fma_f16 v83, v83, v87, v131 op_sel:[1,1,0] op_sel_hi:[1,0,1] neg_lo:[0,1,0]
    v_pk_mul_f16 v128, v88, v92 op_sel:[0,0] op_sel_hi:[0,1]
    v_pk_mul_f16 v129, v89, v93 op_sel:[0,0] op_sel_hi:[0,1]
    v_pk_fma_f16 v88, v88, v92, v128 op_sel:[1,1,0] op_sel_hi:[1,0,1] neg_lo:[0,1,0]
    v_pk_fma_f16 v89, v89, v93, v129 op_sel:[1,1,0] op_sel_hi:[1,0,1] neg_lo:[0,1,0]
    v_pk_mul_f16 v130, v90, v94 op_sel:[0,0] op_sel_hi:[0,1]
    v_pk_mul_f16 v131, v91, v95 op_sel:[0,0] op_sel_hi:[0,1]
    v_pk_fma_f16 v90, v90, v94, v130 op_sel:[1,1,0] op_sel_hi:[1,0,1] neg_lo:[0,1,0]
    v_pk_fma_f16 v91, v91, v95, v131 op_sel:[1,1,0] op_sel_hi:[1,0,1] neg_lo:[0,1,0]
    s_setprio 3
    s_nop 0
    v_mfma_f32_16x16x32_f16 v[16:19], v[72:75], v[64:67], 0
    v_mfma_f32_16x16x32_f16 v[20:23], v[80:83], v[64:67], 0
    v_mfma_f32_16x16x32_f16 v[24:27], v[88:91], v[64:67], 0
    s_setprio 0
    s_nop 0
    ds_read_b128 v[64:67], v156 offset:128
    ds_read_b128 v[68:71], v157 offset:128
    ds_read_b128 v[72:75], v158 offset:128
    ds_read_b128 v[76:79], v159 offset:128
    ds_read_b128 v[80:83], v160 offset:128
    ds_read_b128 v[84:87], v161 offset:128
    ds_read_b128 v[88:91], v162 offset:128
    ds_read_b128 v[92:95], v163 offset:128
    v_mul_f32 v28, v30, v30
    v_mul_f32 v29, v30, v31
    v_fma_f32 v28, -v31, v31, v28
    v_add_f32 v29, v29, v29
    v_mul_f32 v32, v34, v34
    v_mul_f32 v33, v34, v35
    v_fma_f32 v32, -v35, v35, v32
    v_add_f32 v33, v33, v33
    v_mul_f32 v36, v38, v38
    v_mul_f32 v37, v38, v39
    v_fma_f32 v36, -v39, v39, v36
    v_add_f32_e64 v37, v37, v37
    v_cvt_pk_f16_f32 v55, v28, v29
    v_cvt_pk_f16_f32 v50, v32, -v33
    v_cvt_pk_f16_f32 v133, v36, v37
    v_mul_f32 v30, v28, v28
    v_mul_f32 v31, v28, v29
    v_fma_f32 v30, -v29, v29, v30
    v_add_f32 v31, v31, v31
    v_mul_f32 v34, v32, v32
    v_mul_f32 v35, v32, v33
    v_fma_f32 v34, -v33, v33, v34
    v_add_f32 v35, v35, v35
    v_mul_f32 v38, v36, v36
    v_mul_f32 v39, v36, v37
    v_fma_f32 v38, -v37, v37, v38
    s_waitcnt lgkmcnt(8)
    s_nop 0
    v_pk_mul_f16 v128, v96, v100 op_sel:[0,0] op_sel_hi:[0,1]
    v_pk_mul_f16 v129, v97, v101 op_sel:[0,0] op_sel_hi:[0,1]
    v_pk_fma_f16 v96, v96, v100, v128 op_sel:[1,1,0] op_sel_hi:[1,0,1] neg_lo:[0,1,0]
    v_pk_fma_f16 v97, v97, v101, v129 op_sel:[1,1,0] op_sel_hi:[1,0,1] neg_lo:[0,1,0]
    v_pk_mul_f16 v130, v98, v102 op_sel:[0,0] op_sel_hi:[0,1]
    v_pk_mul_f16 v131, v99, v103 op_sel:[0,0] op_sel_hi:[0,1]
    v_pk_fma_f16 v98, v98, v102, v130 op_sel:[1,1,0] op_sel_hi:[1,0,1] neg_lo:[0,1,0]
    v_pk_fma_f16 v99, v99, v103, v131 op_sel:[1,1,0] op_sel_hi:[1,0,1] neg_lo:[0,1,0]
    v_pk_mul_f16 v128, v104, v108 op_sel:[0,0] op_sel_hi:[0,1]
    v_pk_mul_f16 v129, v105, v109 op_sel:[0,0] op_sel_hi:[0,1]
    v_pk_fma_f16 v104, v104, v108, v128 op_sel:[1,1,0] op_sel_hi:[1,0,1] neg_lo:[0,1,0]
    v_pk_fma_f16 v105, v105, v109, v129 op_sel:[1,1,0] op_sel_hi:[1,0,1] neg_lo:[0,1,0]
    v_pk_mul_f16 v130, v106, v110 op_sel:[0,0] op_sel_hi:[0,1]
    v_pk_mul_f16 v131, v107, v111 op_sel:[0,0] op_sel_hi:[0,1]
    v_pk_fma_f16 v106, v106, v110, v130 op_sel:[1,1,0] op_sel_hi:[1,0,1] neg_lo:[0,1,0]
    v_pk_fma_f16 v107, v107, v111, v131 op_sel:[1,1,0] op_sel_hi:[1,0,1] neg_lo:[0,1,0]
    v_pk_mul_f16 v128, v112, v116 op_sel:[0,0] op_sel_hi:[0,1]
    v_pk_mul_f16 v129, v113, v117 op_sel:[0,0] op_sel_hi:[0,1]
    v_pk_fma_f16 v112, v112, v116, v128 op_sel:[1,1,0] op_sel_hi:[1,0,1] neg_lo:[0,1,0]
    v_pk_fma_f16 v113, v113, v117, v129 op_sel:[1,1,0] op_sel_hi:[1,0,1] neg_lo:[0,1,0]
    v_pk_mul_f16 v130, v114, v118 op_sel:[0,0] op_sel_hi:[0,1]
    v_pk_mul_f16 v131, v115, v119 op_sel:[0,0] op_sel_hi:[0,1]
    v_pk_fma_f16 v114, v114, v118, v130 op_sel:[1,1,0] op_sel_hi:[1,0,1] neg_lo:[0,1,0]
    v_pk_fma_f16 v115, v115, v119, v131 op_sel:[1,1,0] op_sel_hi:[1,0,1] neg_lo:[0,1,0]
    v_pk_mul_f16 v128, v120, v124 op_sel:[0,0] op_sel_hi:[0,1]
    v_pk_mul_f16 v129, v121, v125 op_sel:[0,0] op_sel_hi:[0,1]
    v_pk_fma_f16 v120, v120, v124, v128 op_sel:[1,1,0] op_sel_hi:[1,0,1] neg_lo:[0,1,0]
    v_pk_fma_f16 v121, v121, v125, v129 op_sel:[1,1,0] op_sel_hi:[1,0,1] neg_lo:[0,1,0]
    v_pk_mul_f16 v130, v122, v126 op_sel:[0,0] op_sel_hi:[0,1]
    v_pk_mul_f16 v131, v123, v127 op_sel:[0,0] op_sel_hi:[0,1]
    v_pk_fma_f16 v122, v122, v126, v130 op_sel:[1,1,0] op_sel_hi:[1,0,1] neg_lo:[0,1,0]
    v_pk_fma_f16 v123, v123, v127, v131 op_sel:[1,1,0] op_sel_hi:[1,0,1] neg_lo:[0,1,0]
    s_setprio 3
    s_nop 0
    v_mfma_f32_16x16x32_f16 v[16:19], v[104:107], v[96:99], v[16:19]
    v_mfma_f32_16x16x32_f16 v[20:23], v[112:115], v[96:99], v[20:23]
    v_mfma_f32_16x16x32_f16 v[24:27], v[120:123], v[96:99], v[24:27]
    s_setprio 0
    s_nop 0
    ds_read_b128 v[96:99], v156 offset:192
    ds_read_b128 v[100:103], v157 offset:192
    ds_read_b128 v[104:107], v158 offset:192
    ds_read_b128 v[108:111], v159 offset:192
    ds_read_b128 v[112:115], v160 offset:192
    ds_read_b128 v[116:119], v161 offset:192
    ds_read_b128 v[120:123], v162 offset:192
    ds_read_b128 v[124:127], v163 offset:192
    v_add_f32_e64 v39, v39, v39
    v_cvt_pk_f16_f32 v46, v30, -v31
    v_cvt_pk_f16_f32 v136, v34, v35
    v_cvt_pk_f16_f32 v135, v38, v39
    v_pk_mul_f16 v138, v59, v137 op_sel:[0,0] op_sel_hi:[0,1]
    v_pk_mul_f16 v139, v52, v53 op_sel:[0,0] op_sel_hi:[0,1]
    v_pk_fma_f16 v61, v59, v137, v138 op_sel:[1,1,0] op_sel_hi:[1,0,1] neg_lo:[0,1,0]
    v_pk_fma_f16 v54, v52, v53, v139 op_sel:[1,1,0] op_sel_hi:[1,0,1] neg_lo:[0,1,0]
    v_pk_mul_f16 v140, v55, v52 op_sel:[0,0] op_sel_hi:[0,1]
    v_pk_mul_f16 v141, v55, v53 op_sel:[0,0] op_sel_hi:[0,1]
    v_pk_fma_f16 v56, v55, v52, v140 op_sel:[1,1,0] op_sel_hi:[1,0,1] neg_lo:[0,1,0]
    v_pk_fma_f16 v57, v55, v53, v141 op_sel:[1,1,0] op_sel_hi:[1,0,1] neg_lo:[0,1,0]
    v_pk_mul_f16 v138, v55, v54 op_sel:[0,0] op_sel_hi:[0,1]
    v_pk_mul_f16 v139, v49, v50 op_sel:[0,0] op_sel_hi:[0,1]
    v_pk_fma_f16 v58, v55, v54, v138 op_sel:[1,1,0] op_sel_hi:[1,0,1] neg_lo:[0,1,0]
    v_pk_fma_f16 v51, v49, v50, v139 op_sel:[1,1,0] op_sel_hi:[1,0,1] neg_lo:[0,1,0]
    v_pk_mul_f16 v140, v63, v55 op_sel:[0,0] op_sel_hi:[0,1]
    v_pk_mul_f16 v141, v63, v133 op_sel:[0,0] op_sel_hi:[0,1]
    v_pk_fma_f16 v132, v63, v55, v140 op_sel:[1,1,0] op_sel_hi:[1,0,1] neg_lo:[0,1,0]
    v_pk_fma_f16 v134, v63, v133, v141 op_sel:[1,1,0] op_sel_hi:[1,0,1] neg_lo:[0,1,0]
    v_pk_mul_f16 v138, v46, v47 op_sel:[0,0] op_sel_hi:[0,1]
    v_pk_mul_f16 v139, v59, v136 op_sel:[0,0] op_sel_hi:[0,1]
    v_pk_fma_f16 v48, v46, v47, v138 op_sel:[1,1,0] op_sel_hi:[1,0,1] neg_lo:[0,1,0]
    v_pk_fma_f16 v60, v59, v136, v139 op_sel:[1,1,0] op_sel_hi:[1,0,1] neg_lo:[0,1,0]
    v_pk_mul_f16 v140, v61, v136 op_sel:[0,0] op_sel_hi:[0,1]
    v_pk_fma_f16 v62, v61, v136, v140 op_sel:[1,1,0] op_sel_hi:[1,0,1] neg_lo:[0,1,0]
    s_waitcnt lgkmcnt(8)
    s_nop 0
    v_pk_mul_f16 v128, v64, v68 op_sel:[0,0] op_sel_hi:[0,1]
    v_pk_mul_f16 v129, v65, v69 op_sel:[0,0] op_sel_hi:[0,1]
    v_pk_fma_f16 v64, v64, v68, v128 op_sel:[1,1,0] op_sel_hi:[1,0,1] neg_lo:[0,1,0]
    v_pk_fma_f16 v65, v65, v69, v129 op_sel:[1,1,0] op_sel_hi:[1,0,1] neg_lo:[0,1,0]
    v_pk_mul_f16 v130, v66, v70 op_sel:[0,0] op_sel_hi:[0,1]
    v_pk_mul_f16 v131, v67, v71 op_sel:[0,0] op_sel_hi:[0,1]
    v_pk_fma_f16 v66, v66, v70, v130 op_sel:[1,1,0] op_sel_hi:[1,0,1] neg_lo:[0,1,0]
    v_pk_fma_f16 v67, v67, v71, v131 op_sel:[1,1,0] op_sel_hi:[1,0,1] neg_lo:[0,1,0]
    v_pk_mul_f16 v128, v72, v76 op_sel:[0,0] op_sel_hi:[0,1]
    v_pk_mul_f16 v129, v73, v77 op_sel:[0,0] op_sel_hi:[0,1]
    v_pk_fma_f16 v72, v72, v76, v128 op_sel:[1,1,0] op_sel_hi:[1,0,1] neg_lo:[0,1,0]
    v_pk_fma_f16 v73, v73, v77, v129 op_sel:[1,1,0] op_sel_hi:[1,0,1] neg_lo:[0,1,0]
    v_pk_mul_f16 v130, v74, v78 op_sel:[0,0] op_sel_hi:[0,1]
    v_pk_mul_f16 v131, v75, v79 op_sel:[0,0] op_sel_hi:[0,1]
    v_pk_fma_f16 v74, v74, v78, v130 op_sel:[1,1,0] op_sel_hi:[1,0,1] neg_lo:[0,1,0]
    v_pk_fma_f16 v75, v75, v79, v131 op_sel:[1,1,0] op_sel_hi:[1,0,1] neg_lo:[0,1,0]
    v_pk_mul_f16 v128, v80, v84 op_sel:[0,0] op_sel_hi:[0,1]
    v_pk_mul_f16 v129, v81, v85 op_sel:[0,0] op_sel_hi:[0,1]
    v_pk_fma_f16 v80, v80, v84, v128 op_sel:[1,1,0] op_sel_hi:[1,0,1] neg_lo:[0,1,0]
    v_pk_fma_f16 v81, v81, v85, v129 op_sel:[1,1,0] op_sel_hi:[1,0,1] neg_lo:[0,1,0]
    v_pk_mul_f16 v130, v82, v86 op_sel:[0,0] op_sel_hi:[0,1]
    v_pk_mul_f16 v131, v83, v87 op_sel:[0,0] op_sel_hi:[0,1]
    v_pk_fma_f16 v82, v82, v86, v130 op_sel:[1,1,0] op_sel_hi:[1,0,1] neg_lo:[0,1,0]
    v_pk_fma_f16 v83, v83, v87, v131 op_sel:[1,1,0] op_sel_hi:[1,0,1] neg_lo:[0,1,0]
    v_pk_mul_f16 v128, v88, v92 op_sel:[0,0] op_sel_hi:[0,1]
    v_pk_mul_f16 v129, v89, v93 op_sel:[0,0] op_sel_hi:[0,1]
    v_pk_fma_f16 v88, v88, v92, v128 op_sel:[1,1,0] op_sel_hi:[1,0,1] neg_lo:[0,1,0]
    v_pk_fma_f16 v89, v89, v93, v129 op_sel:[1,1,0] op_sel_hi:[1,0,1] neg_lo:[0,1,0]
    v_pk_mul_f16 v130, v90, v94 op_sel:[0,0] op_sel_hi:[0,1]
    v_pk_mul_f16 v131, v91, v95 op_sel:[0,0] op_sel_hi:[0,1]
    v_pk_fma_f16 v90, v90, v94, v130 op_sel:[1,1,0] op_sel_hi:[1,0,1] neg_lo:[0,1,0]
    v_pk_fma_f16 v91, v91, v95, v131 op_sel:[1,1,0] op_sel_hi:[1,0,1] neg_lo:[0,1,0]
    s_setprio 3
    s_nop 0
    v_mfma_f32_16x16x32_f16 v[16:19], v[72:75], v[64:67], v[16:19]
    v_mfma_f32_16x16x32_f16 v[20:23], v[80:83], v[64:67], v[20:23]
    v_mfma_f32_16x16x32_f16 v[24:27], v[88:91], v[64:67], v[24:27]
    s_setprio 0
    s_waitcnt lgkmcnt(0)
    v_pk_mul_f16 v128, v96, v100 op_sel:[0,0] op_sel_hi:[0,1]
    v_pk_mul_f16 v129, v97, v101 op_sel:[0,0] op_sel_hi:[0,1]
    v_pk_fma_f16 v96, v96, v100, v128 op_sel:[1,1,0] op_sel_hi:[1,0,1] neg_lo:[0,1,0]
    ds_write2_b32 v150, v46, v47 offset0:0 offset1:68
    v_pk_fma_f16 v97, v97, v101, v129 op_sel:[1,1,0] op_sel_hi:[1,0,1] neg_lo:[0,1,0]
    v_pk_mul_f16 v130, v98, v102 op_sel:[0,0] op_sel_hi:[0,1]
    v_pk_mul_f16 v131, v99, v103 op_sel:[0,0] op_sel_hi:[0,1]
    ds_write2_b32 v150, v48, v164 offset0:136 offset1:204
    v_pk_fma_f16 v98, v98, v102, v130 op_sel:[1,1,0] op_sel_hi:[1,0,1] neg_lo:[0,1,0]
    v_pk_fma_f16 v99, v99, v103, v131 op_sel:[1,1,0] op_sel_hi:[1,0,1] neg_lo:[0,1,0]
    v_pk_mul_f16 v128, v104, v108 op_sel:[0,0] op_sel_hi:[0,1]
    ds_write2_b32 v151, v49, v50 offset0:0 offset1:68
    v_pk_mul_f16 v129, v105, v109 op_sel:[0,0] op_sel_hi:[0,1]
    v_pk_fma_f16 v104, v104, v108, v128 op_sel:[1,1,0] op_sel_hi:[1,0,1] neg_lo:[0,1,0]
    v_pk_fma_f16 v105, v105, v109, v129 op_sel:[1,1,0] op_sel_hi:[1,0,1] neg_lo:[0,1,0]
    ds_write2_b32 v151, v51, v164 offset0:136 offset1:204
    v_pk_mul_f16 v130, v106, v110 op_sel:[0,0] op_sel_hi:[0,1]
    v_pk_mul_f16 v131, v107, v111 op_sel:[0,0] op_sel_hi:[0,1]
    v_pk_fma_f16 v106, v106, v110, v130 op_sel:[1,1,0] op_sel_hi:[1,0,1] neg_lo:[0,1,0]
    ds_write2_b32 v152, v52, v53 offset0:0 offset1:68
    v_pk_fma_f16 v107, v107, v111, v131 op_sel:[1,1,0] op_sel_hi:[1,0,1] neg_lo:[0,1,0]
    v_pk_mul_f16 v128, v112, v116 op_sel:[0,0] op_sel_hi:[0,1]
    v_pk_mul_f16 v129, v113, v117 op_sel:[0,0] op_sel_hi:[0,1]
    ds_write2_b32 v152, v54, v55 offset0:136 offset1:204
    v_pk_fma_f16 v112, v112, v116, v128 op_sel:[1,1,0] op_sel_hi:[1,0,1] neg_lo:[0,1,0]
    v_pk_fma_f16 v113, v113, v117, v129 op_sel:[1,1,0] op_sel_hi:[1,0,1] neg_lo:[0,1,0]
    v_pk_mul_f16 v130, v114, v118 op_sel:[0,0] op_sel_hi:[0,1]
    ds_write2_b32 v153, v56, v57 offset0:0 offset1:68
    v_pk_mul_f16 v131, v115, v119 op_sel:[0,0] op_sel_hi:[0,1]
    v_pk_fma_f16 v114, v114, v118, v130 op_sel:[1,1,0] op_sel_hi:[1,0,1] neg_lo:[0,1,0]
    v_pk_fma_f16 v115, v115, v119, v131 op_sel:[1,1,0] op_sel_hi:[1,0,1] neg_lo:[0,1,0]
    ds_write2_b32 v153, v58, v59 offset0:136 offset1:204
    v_pk_mul_f16 v128, v120, v124 op_sel:[0,0] op_sel_hi:[0,1]
    v_pk_mul_f16 v129, v121, v125 op_sel:[0,0] op_sel_hi:[0,1]
    v_pk_fma_f16 v120, v120, v124, v128 op_sel:[1,1,0] op_sel_hi:[1,0,1] neg_lo:[0,1,0]
    ds_write2_b32 v154, v60, v61 offset0:0 offset1:68
    v_pk_fma_f16 v121, v121, v125, v129 op_sel:[1,1,0] op_sel_hi:[1,0,1] neg_lo:[0,1,0]
    v_pk_mul_f16 v130, v122, v126 op_sel:[0,0] op_sel_hi:[0,1]
    v_pk_mul_f16 v131, v123, v127 op_sel:[0,0] op_sel_hi:[0,1]
    ds_write2_b32 v154, v62, v63 offset0:136 offset1:204
    v_pk_fma_f16 v122, v122, v126, v130 op_sel:[1,1,0] op_sel_hi:[1,0,1] neg_lo:[0,1,0]
    v_pk_fma_f16 v123, v123, v127, v131 op_sel:[1,1,0] op_sel_hi:[1,0,1] neg_lo:[0,1,0]
    ds_write2_b32 v155, v132, v133 offset0:0 offset1:68
    ds_write2_b32 v155, v134, v135 offset0:136 offset1:204
    s_setprio 3
    s_nop 0
    v_mfma_f32_16x16x32_f16 v[16:19], v[104:107], v[96:99], v[16:19]
    v_mfma_f32_16x16x32_f16 v[20:23], v[112:115], v[96:99], v[20:23]
    v_mfma_f32_16x16x32_f16 v[24:27], v[120:123], v[96:99], v[24:27]
    s_setprio 0
    s_nop 0
    ds_read_b128 v[64:67], v156 offset:0
    ds_read_b128 v[68:71], v157 offset:0
    ds_read_b128 v[72:75], v158 offset:0
    ds_read_b128 v[76:79], v159 offset:0
    ds_read_b128 v[80:83], v160 offset:0
    ds_read_b128 v[84:87], v161 offset:0
    ds_read_b128 v[88:91], v162 offset:0
    ds_read_b128 v[92:95], v163 offset:0
    ds_read_b128 v[96:99], v156 offset:64
    ds_read_b128 v[100:103], v157 offset:64
    ds_read_b128 v[104:107], v158 offset:64
    ds_read_b128 v[108:111], v159 offset:64
    ds_read_b128 v[112:115], v160 offset:64
    ds_read_b128 v[116:119], v161 offset:64
    ds_read_b128 v[120:123], v162 offset:64
    ds_read_b128 v[124:127], v163 offset:64
    v_exp_f32 v40, v9
    v_fract_f32 v41, v10
    v_mul_f32 v42, 16.0, v9
    v_cos_f32 v28, v41
    v_sin_f32 v29, v41
    v_mul_f32 v43, 16.0, v10
    v_mul_f32 v28, v28, v40
    v_mul_f32 v29, v29, v40
    v_exp_f32 v42, v42
    v_fract_f32 v43, v43
    v_mul_f32 v44, 256.0, v9
    v_cos_f32 v32, v43
    v_sin_f32 v33, v43
    v_mul_f32 v45, 256.0, v10
    v_mul_f32 v32, v32, v42
    v_mul_f32 v33, v33, v42
    v_exp_f32 v44, v44
    v_fract_f32 v45, v45
    v_cvt_pk_f16_f32 v59, v11, v12
    v_cos_f32 v36, v45
    v_sin_f32 v37, v45
    v_cvt_pk_f16_f32 v52, v28, v29
    v_mul_f32 v36, v36, v44
    v_mul_f32 v37, v37, v44
    v_cvt_pk_f16_f32 v47, v32, -v33
    v_cvt_pk_f16_f32 v137, v36, v37
    v_mul_f32 v30, v28, v28
    v_mul_f32 v31, v28, v29
    v_fma_f32 v30, -v29, v29, v30
    v_add_f32 v31, v31, v31
    v_mul_f32 v34, v32, v32
    v_mul_f32 v35, v32, v33
    v_fma_f32 v34, -v33, v33, v34
    v_add_f32 v35, v35, v35
    v_mul_f32 v38, v36, v36
    v_mul_f32 v39, v36, v37
    v_fma_f32 v38, -v37, v37, v38
    v_add_f32_e64 v39, v39, v39
    v_cvt_pk_f16_f32 v53, v30, v31
    v_cvt_pk_f16_f32 v49, v34, -v35
    v_cvt_pk_f16_f32 v63, v38, v39
    s_waitcnt lgkmcnt(8)
    s_nop 0
    v_pk_mul_f16 v128, v64, v68 op_sel:[0,0] op_sel_hi:[0,1]
    v_pk_mul_f16 v129, v65, v69 op_sel:[0,0] op_sel_hi:[0,1]
    v_pk_fma_f16 v64, v64, v68, v128 op_sel:[1,1,0] op_sel_hi:[1,0,1] neg_lo:[0,1,0]
    v_pk_fma_f16 v65, v65, v69, v129 op_sel:[1,1,0] op_sel_hi:[1,0,1] neg_lo:[0,1,0]
    v_pk_mul_f16 v130, v66, v70 op_sel:[0,0] op_sel_hi:[0,1]
    v_pk_mul_f16 v131, v67, v71 op_sel:[0,0] op_sel_hi:[0,1]
    v_pk_fma_f16 v66, v66, v70, v130 op_sel:[1,1,0] op_sel_hi:[1,0,1] neg_lo:[0,1,0]
    v_pk_fma_f16 v67, v67, v71, v131 op_sel:[1,1,0] op_sel_hi:[1,0,1] neg_lo:[0,1,0]
    v_pk_mul_f16 v128, v72, v76 op_sel:[0,0] op_sel_hi:[0,1]
    v_pk_mul_f16 v129, v73, v77 op_sel:[0,0] op_sel_hi:[0,1]
    v_pk_fma_f16 v72, v72, v76, v128 op_sel:[1,1,0] op_sel_hi:[1,0,1] neg_lo:[0,1,0]
    v_pk_fma_f16 v73, v73, v77, v129 op_sel:[1,1,0] op_sel_hi:[1,0,1] neg_lo:[0,1,0]
    v_pk_mul_f16 v130, v74, v78 op_sel:[0,0] op_sel_hi:[0,1]
    v_pk_mul_f16 v131, v75, v79 op_sel:[0,0] op_sel_hi:[0,1]
    v_pk_fma_f16 v74, v74, v78, v130 op_sel:[1,1,0] op_sel_hi:[1,0,1] neg_lo:[0,1,0]
    v_pk_fma_f16 v75, v75, v79, v131 op_sel:[1,1,0] op_sel_hi:[1,0,1] neg_lo:[0,1,0]
    v_pk_mul_f16 v128, v80, v84 op_sel:[0,0] op_sel_hi:[0,1]
    v_pk_mul_f16 v129, v81, v85 op_sel:[0,0] op_sel_hi:[0,1]
    v_pk_fma_f16 v80, v80, v84, v128 op_sel:[1,1,0] op_sel_hi:[1,0,1] neg_lo:[0,1,0]
    v_pk_fma_f16 v81, v81, v85, v129 op_sel:[1,1,0] op_sel_hi:[1,0,1] neg_lo:[0,1,0]
    v_pk_mul_f16 v130, v82, v86 op_sel:[0,0] op_sel_hi:[0,1]
    v_pk_mul_f16 v131, v83, v87 op_sel:[0,0] op_sel_hi:[0,1]
    v_pk_fma_f16 v82, v82, v86, v130 op_sel:[1,1,0] op_sel_hi:[1,0,1] neg_lo:[0,1,0]
    v_pk_fma_f16 v83, v83, v87, v131 op_sel:[1,1,0] op_sel_hi:[1,0,1] neg_lo:[0,1,0]
    v_pk_mul_f16 v128, v88, v92 op_sel:[0,0] op_sel_hi:[0,1]
    v_pk_mul_f16 v129, v89, v93 op_sel:[0,0] op_sel_hi:[0,1]
    v_pk_fma_f16 v88, v88, v92, v128 op_sel:[1,1,0] op_sel_hi:[1,0,1] neg_lo:[0,1,0]
    v_pk_fma_f16 v89, v89, v93, v129 op_sel:[1,1,0] op_sel_hi:[1,0,1] neg_lo:[0,1,0]
    v_pk_mul_f16 v130, v90, v94 op_sel:[0,0] op_sel_hi:[0,1]
    v_pk_mul_f16 v131, v91, v95 op_sel:[0,0] op_sel_hi:[0,1]
    v_pk_fma_f16 v90, v90, v94, v130 op_sel:[1,1,0] op_sel_hi:[1,0,1] neg_lo:[0,1,0]
    v_pk_fma_f16 v91, v91, v95, v131 op_sel:[1,1,0] op_sel_hi:[1,0,1] neg_lo:[0,1,0]
    s_setprio 3
    s_nop 0
    v_mfma_f32_16x16x32_f16 v[16:19], v[72:75], v[64:67], v[16:19]
    v_mfma_f32_16x16x32_f16 v[20:23], v[80:83], v[64:67], v[20:23]
    v_mfma_f32_16x16x32_f16 v[24:27], v[88:91], v[64:67], v[24:27]
    s_setprio 0
    s_nop 0
    ds_read_b128 v[64:67], v156 offset:128
    ds_read_b128 v[68:71], v157 offset:128
    ds_read_b128 v[72:75], v158 offset:128
    ds_read_b128 v[76:79], v159 offset:128
    ds_read_b128 v[80:83], v160 offset:128
    ds_read_b128 v[84:87], v161 offset:128
    ds_read_b128 v[88:91], v162 offset:128
    ds_read_b128 v[92:95], v163 offset:128
    v_mul_f32 v28, v30, v30
    v_mul_f32 v29, v30, v31
    v_fma_f32 v28, -v31, v31, v28
    v_add_f32 v29, v29, v29
    v_mul_f32 v32, v34, v34
    v_mul_f32 v33, v34, v35
    v_fma_f32 v32, -v35, v35, v32
    v_add_f32 v33, v33, v33
    v_mul_f32 v36, v38, v38
    v_mul_f32 v37, v38, v39
    v_fma_f32 v36, -v39, v39, v36
    v_add_f32_e64 v37, v37, v37
    v_cvt_pk_f16_f32 v55, v28, v29
    v_cvt_pk_f16_f32 v50, v32, -v33
    v_cvt_pk_f16_f32 v133, v36, v37
    v_mul_f32 v30, v28, v28
    v_mul_f32 v31, v28, v29
    v_fma_f32 v30, -v29, v29, v30
    v_add_f32 v31, v31, v31
    v_mul_f32 v34, v32, v32
    v_mul_f32 v35, v32, v33
    v_fma_f32 v34, -v33, v33, v34
    v_add_f32 v35, v35, v35
    v_mul_f32 v38, v36, v36
    v_mul_f32 v39, v36, v37
    v_fma_f32 v38, -v37, v37, v38
    s_waitcnt lgkmcnt(8)
    s_nop 0
    v_pk_mul_f16 v128, v96, v100 op_sel:[0,0] op_sel_hi:[0,1]
    v_pk_mul_f16 v129, v97, v101 op_sel:[0,0] op_sel_hi:[0,1]
    v_pk_fma_f16 v96, v96, v100, v128 op_sel:[1,1,0] op_sel_hi:[1,0,1] neg_lo:[0,1,0]
    v_pk_fma_f16 v97, v97, v101, v129 op_sel:[1,1,0] op_sel_hi:[1,0,1] neg_lo:[0,1,0]
    v_pk_mul_f16 v130, v98, v102 op_sel:[0,0] op_sel_hi:[0,1]
    v_pk_mul_f16 v131, v99, v103 op_sel:[0,0] op_sel_hi:[0,1]
    v_pk_fma_f16 v98, v98, v102, v130 op_sel:[1,1,0] op_sel_hi:[1,0,1] neg_lo:[0,1,0]
    v_pk_fma_f16 v99, v99, v103, v131 op_sel:[1,1,0] op_sel_hi:[1,0,1] neg_lo:[0,1,0]
    v_pk_mul_f16 v128, v104, v108 op_sel:[0,0] op_sel_hi:[0,1]
    v_pk_mul_f16 v129, v105, v109 op_sel:[0,0] op_sel_hi:[0,1]
    v_pk_fma_f16 v104, v104, v108, v128 op_sel:[1,1,0] op_sel_hi:[1,0,1] neg_lo:[0,1,0]
    v_pk_fma_f16 v105, v105, v109, v129 op_sel:[1,1,0] op_sel_hi:[1,0,1] neg_lo:[0,1,0]
    v_pk_mul_f16 v130, v106, v110 op_sel:[0,0] op_sel_hi:[0,1]
    v_pk_mul_f16 v131, v107, v111 op_sel:[0,0] op_sel_hi:[0,1]
    v_pk_fma_f16 v106, v106, v110, v130 op_sel:[1,1,0] op_sel_hi:[1,0,1] neg_lo:[0,1,0]
    v_pk_fma_f16 v107, v107, v111, v131 op_sel:[1,1,0] op_sel_hi:[1,0,1] neg_lo:[0,1,0]
    v_pk_mul_f16 v128, v112, v116 op_sel:[0,0] op_sel_hi:[0,1]
    v_pk_mul_f16 v129, v113, v117 op_sel:[0,0] op_sel_hi:[0,1]
    v_pk_fma_f16 v112, v112, v116, v128 op_sel:[1,1,0] op_sel_hi:[1,0,1] neg_lo:[0,1,0]
    v_pk_fma_f16 v113, v113, v117, v129 op_sel:[1,1,0] op_sel_hi:[1,0,1] neg_lo:[0,1,0]
    v_pk_mul_f16 v130, v114, v118 op_sel:[0,0] op_sel_hi:[0,1]
    v_pk_mul_f16 v131, v115, v119 op_sel:[0,0] op_sel_hi:[0,1]
    v_pk_fma_f16 v114, v114, v118, v130 op_sel:[1,1,0] op_sel_hi:[1,0,1] neg_lo:[0,1,0]
    v_pk_fma_f16 v115, v115, v119, v131 op_sel:[1,1,0] op_sel_hi:[1,0,1] neg_lo:[0,1,0]
    v_pk_mul_f16 v128, v120, v124 op_sel:[0,0] op_sel_hi:[0,1]
    v_pk_mul_f16 v129, v121, v125 op_sel:[0,0] op_sel_hi:[0,1]
    v_pk_fma_f16 v120, v120, v124, v128 op_sel:[1,1,0] op_sel_hi:[1,0,1] neg_lo:[0,1,0]
    v_pk_fma_f16 v121, v121, v125, v129 op_sel:[1,1,0] op_sel_hi:[1,0,1] neg_lo:[0,1,0]
    v_pk_mul_f16 v130, v122, v126 op_sel:[0,0] op_sel_hi:[0,1]
    v_pk_mul_f16 v131, v123, v127 op_sel:[0,0] op_sel_hi:[0,1]
    v_pk_fma_f16 v122, v122, v126, v130 op_sel:[1,1,0] op_sel_hi:[1,0,1] neg_lo:[0,1,0]
    v_pk_fma_f16 v123, v123, v127, v131 op_sel:[1,1,0] op_sel_hi:[1,0,1] neg_lo:[0,1,0]
    s_setprio 3
    s_nop 0
    v_mfma_f32_16x16x32_f16 v[16:19], v[104:107], v[96:99], v[16:19]
    v_mfma_f32_16x16x32_f16 v[20:23], v[112:115], v[96:99], v[20:23]
    v_mfma_f32_16x16x32_f16 v[24:27], v[120:123], v[96:99], v[24:27]
    s_setprio 0
    s_nop 0
    ds_read_b128 v[96:99], v156 offset:192
    ds_read_b128 v[100:103], v157 offset:192
    ds_read_b128 v[104:107], v158 offset:192
    ds_read_b128 v[108:111], v159 offset:192
    ds_read_b128 v[112:115], v160 offset:192
    ds_read_b128 v[116:119], v161 offset:192
    ds_read_b128 v[120:123], v162 offset:192
    ds_read_b128 v[124:127], v163 offset:192
    v_add_f32_e64 v39, v39, v39
    v_cvt_pk_f16_f32 v46, v30, -v31
    v_cvt_pk_f16_f32 v136, v34, v35
    v_cvt_pk_f16_f32 v135, v38, v39
    v_pk_mul_f16 v138, v59, v137 op_sel:[0,0] op_sel_hi:[0,1]
    v_pk_mul_f16 v139, v52, v53 op_sel:[0,0] op_sel_hi:[0,1]
    v_pk_fma_f16 v61, v59, v137, v138 op_sel:[1,1,0] op_sel_hi:[1,0,1] neg_lo:[0,1,0]
    v_pk_fma_f16 v54, v52, v53, v139 op_sel:[1,1,0] op_sel_hi:[1,0,1] neg_lo:[0,1,0]
    v_pk_mul_f16 v140, v55, v52 op_sel:[0,0] op_sel_hi:[0,1]
    v_pk_mul_f16 v141, v55, v53 op_sel:[0,0] op_sel_hi:[0,1]
    v_pk_fma_f16 v56, v55, v52, v140 op_sel:[1,1,0] op_sel_hi:[1,0,1] neg_lo:[0,1,0]
    v_pk_fma_f16 v57, v55, v53, v141 op_sel:[1,1,0] op_sel_hi:[1,0,1] neg_lo:[0,1,0]
    v_pk_mul_f16 v138, v55, v54 op_sel:[0,0] op_sel_hi:[0,1]
    v_pk_mul_f16 v139, v49, v50 op_sel:[0,0] op_sel_hi:[0,1]
    v_pk_fma_f16 v58, v55, v54, v138 op_sel:[1,1,0] op_sel_hi:[1,0,1] neg_lo:[0,1,0]
    v_pk_fma_f16 v51, v49, v50, v139 op_sel:[1,1,0] op_sel_hi:[1,0,1] neg_lo:[0,1,0]
    v_pk_mul_f16 v140, v63, v55 op_sel:[0,0] op_sel_hi:[0,1]
    v_pk_mul_f16 v141, v63, v133 op_sel:[0,0] op_sel_hi:[0,1]
    v_pk_fma_f16 v132, v63, v55, v140 op_sel:[1,1,0] op_sel_hi:[1,0,1] neg_lo:[0,1,0]
    v_pk_fma_f16 v134, v63, v133, v141 op_sel:[1,1,0] op_sel_hi:[1,0,1] neg_lo:[0,1,0]
    v_pk_mul_f16 v138, v46, v47 op_sel:[0,0] op_sel_hi:[0,1]
    v_pk_mul_f16 v139, v59, v136 op_sel:[0,0] op_sel_hi:[0,1]
    v_pk_fma_f16 v48, v46, v47, v138 op_sel:[1,1,0] op_sel_hi:[1,0,1] neg_lo:[0,1,0]
    v_pk_fma_f16 v60, v59, v136, v139 op_sel:[1,1,0] op_sel_hi:[1,0,1] neg_lo:[0,1,0]
    v_pk_mul_f16 v140, v61, v136 op_sel:[0,0] op_sel_hi:[0,1]
    v_pk_fma_f16 v62, v61, v136, v140 op_sel:[1,1,0] op_sel_hi:[1,0,1] neg_lo:[0,1,0]
    s_waitcnt lgkmcnt(8)
    s_nop 0
    v_pk_mul_f16 v128, v64, v68 op_sel:[0,0] op_sel_hi:[0,1]
    v_pk_mul_f16 v129, v65, v69 op_sel:[0,0] op_sel_hi:[0,1]
    v_pk_fma_f16 v64, v64, v68, v128 op_sel:[1,1,0] op_sel_hi:[1,0,1] neg_lo:[0,1,0]
    v_pk_fma_f16 v65, v65, v69, v129 op_sel:[1,1,0] op_sel_hi:[1,0,1] neg_lo:[0,1,0]
    v_pk_mul_f16 v130, v66, v70 op_sel:[0,0] op_sel_hi:[0,1]
    v_pk_mul_f16 v131, v67, v71 op_sel:[0,0] op_sel_hi:[0,1]
    v_pk_fma_f16 v66, v66, v70, v130 op_sel:[1,1,0] op_sel_hi:[1,0,1] neg_lo:[0,1,0]
    v_pk_fma_f16 v67, v67, v71, v131 op_sel:[1,1,0] op_sel_hi:[1,0,1] neg_lo:[0,1,0]
    v_pk_mul_f16 v128, v72, v76 op_sel:[0,0] op_sel_hi:[0,1]
    v_pk_mul_f16 v129, v73, v77 op_sel:[0,0] op_sel_hi:[0,1]
    v_pk_fma_f16 v72, v72, v76, v128 op_sel:[1,1,0] op_sel_hi:[1,0,1] neg_lo:[0,1,0]
    v_pk_fma_f16 v73, v73, v77, v129 op_sel:[1,1,0] op_sel_hi:[1,0,1] neg_lo:[0,1,0]
    v_pk_mul_f16 v130, v74, v78 op_sel:[0,0] op_sel_hi:[0,1]
    v_pk_mul_f16 v131, v75, v79 op_sel:[0,0] op_sel_hi:[0,1]
    v_pk_fma_f16 v74, v74, v78, v130 op_sel:[1,1,0] op_sel_hi:[1,0,1] neg_lo:[0,1,0]
    v_pk_fma_f16 v75, v75, v79, v131 op_sel:[1,1,0] op_sel_hi:[1,0,1] neg_lo:[0,1,0]
    v_pk_mul_f16 v128, v80, v84 op_sel:[0,0] op_sel_hi:[0,1]
    v_pk_mul_f16 v129, v81, v85 op_sel:[0,0] op_sel_hi:[0,1]
    v_pk_fma_f16 v80, v80, v84, v128 op_sel:[1,1,0] op_sel_hi:[1,0,1] neg_lo:[0,1,0]
    v_pk_fma_f16 v81, v81, v85, v129 op_sel:[1,1,0] op_sel_hi:[1,0,1] neg_lo:[0,1,0]
    v_pk_mul_f16 v130, v82, v86 op_sel:[0,0] op_sel_hi:[0,1]
    v_pk_mul_f16 v131, v83, v87 op_sel:[0,0] op_sel_hi:[0,1]
    v_pk_fma_f16 v82, v82, v86, v130 op_sel:[1,1,0] op_sel_hi:[1,0,1] neg_lo:[0,1,0]
    v_pk_fma_f16 v83, v83, v87, v131 op_sel:[1,1,0] op_sel_hi:[1,0,1] neg_lo:[0,1,0]
    v_pk_mul_f16 v128, v88, v92 op_sel:[0,0] op_sel_hi:[0,1]
    v_pk_mul_f16 v129, v89, v93 op_sel:[0,0] op_sel_hi:[0,1]
    v_pk_fma_f16 v88, v88, v92, v128 op_sel:[1,1,0] op_sel_hi:[1,0,1] neg_lo:[0,1,0]
    v_pk_fma_f16 v89, v89, v93, v129 op_sel:[1,1,0] op_sel_hi:[1,0,1] neg_lo:[0,1,0]
    v_pk_mul_f16 v130, v90, v94 op_sel:[0,0] op_sel_hi:[0,1]
    v_pk_mul_f16 v131, v91, v95 op_sel:[0,0] op_sel_hi:[0,1]
    v_pk_fma_f16 v90, v90, v94, v130 op_sel:[1,1,0] op_sel_hi:[1,0,1] neg_lo:[0,1,0]
    v_pk_fma_f16 v91, v91, v95, v131 op_sel:[1,1,0] op_sel_hi:[1,0,1] neg_lo:[0,1,0]
    s_setprio 3
    s_nop 0
    v_mfma_f32_16x16x32_f16 v[16:19], v[72:75], v[64:67], v[16:19]
    v_mfma_f32_16x16x32_f16 v[20:23], v[80:83], v[64:67], v[20:23]
    v_mfma_f32_16x16x32_f16 v[24:27], v[88:91], v[64:67], v[24:27]
    s_setprio 0
    s_waitcnt lgkmcnt(0)
    v_pk_mul_f16 v128, v96, v100 op_sel:[0,0] op_sel_hi:[0,1]
    v_pk_mul_f16 v129, v97, v101 op_sel:[0,0] op_sel_hi:[0,1]
    v_pk_fma_f16 v96, v96, v100, v128 op_sel:[1,1,0] op_sel_hi:[1,0,1] neg_lo:[0,1,0]
    ds_write2_b32 v150, v46, v47 offset0:0 offset1:68
    v_pk_fma_f16 v97, v97, v101, v129 op_sel:[1,1,0] op_sel_hi:[1,0,1] neg_lo:[0,1,0]
    v_pk_mul_f16 v130, v98, v102 op_sel:[0,0] op_sel_hi:[0,1]
    v_pk_mul_f16 v131, v99, v103 op_sel:[0,0] op_sel_hi:[0,1]
    ds_write2_b32 v150, v48, v164 offset0:136 offset1:204
    v_pk_fma_f16 v98, v98, v102, v130 op_sel:[1,1,0] op_sel_hi:[1,0,1] neg_lo:[0,1,0]
    v_pk_fma_f16 v99, v99, v103, v131 op_sel:[1,1,0] op_sel_hi:[1,0,1] neg_lo:[0,1,0]
    v_pk_mul_f16 v128, v104, v108 op_sel:[0,0] op_sel_hi:[0,1]
    ds_write2_b32 v151, v49, v50 offset0:0 offset1:68
    v_pk_mul_f16 v129, v105, v109 op_sel:[0,0] op_sel_hi:[0,1]
    v_pk_fma_f16 v104, v104, v108, v128 op_sel:[1,1,0] op_sel_hi:[1,0,1] neg_lo:[0,1,0]
    v_pk_fma_f16 v105, v105, v109, v129 op_sel:[1,1,0] op_sel_hi:[1,0,1] neg_lo:[0,1,0]
    ds_write2_b32 v151, v51, v164 offset0:136 offset1:204
    v_pk_mul_f16 v130, v106, v110 op_sel:[0,0] op_sel_hi:[0,1]
    v_pk_mul_f16 v131, v107, v111 op_sel:[0,0] op_sel_hi:[0,1]
    v_pk_fma_f16 v106, v106, v110, v130 op_sel:[1,1,0] op_sel_hi:[1,0,1] neg_lo:[0,1,0]
    ds_write2_b32 v152, v52, v53 offset0:0 offset1:68
    v_pk_fma_f16 v107, v107, v111, v131 op_sel:[1,1,0] op_sel_hi:[1,0,1] neg_lo:[0,1,0]
    v_pk_mul_f16 v128, v112, v116 op_sel:[0,0] op_sel_hi:[0,1]
    v_pk_mul_f16 v129, v113, v117 op_sel:[0,0] op_sel_hi:[0,1]
    ds_write2_b32 v152, v54, v55 offset0:136 offset1:204
    v_pk_fma_f16 v112, v112, v116, v128 op_sel:[1,1,0] op_sel_hi:[1,0,1] neg_lo:[0,1,0]
    v_pk_fma_f16 v113, v113, v117, v129 op_sel:[1,1,0] op_sel_hi:[1,0,1] neg_lo:[0,1,0]
    v_pk_mul_f16 v130, v114, v118 op_sel:[0,0] op_sel_hi:[0,1]
    ds_write2_b32 v153, v56, v57 offset0:0 offset1:68
    v_pk_mul_f16 v131, v115, v119 op_sel:[0,0] op_sel_hi:[0,1]
    v_pk_fma_f16 v114, v114, v118, v130 op_sel:[1,1,0] op_sel_hi:[1,0,1] neg_lo:[0,1,0]
    v_pk_fma_f16 v115, v115, v119, v131 op_sel:[1,1,0] op_sel_hi:[1,0,1] neg_lo:[0,1,0]
    ds_write2_b32 v153, v58, v59 offset0:136 offset1:204
    v_pk_mul_f16 v128, v120, v124 op_sel:[0,0] op_sel_hi:[0,1]
    v_pk_mul_f16 v129, v121, v125 op_sel:[0,0] op_sel_hi:[0,1]
    v_pk_fma_f16 v120, v120, v124, v128 op_sel:[1,1,0] op_sel_hi:[1,0,1] neg_lo:[0,1,0]
    ds_write2_b32 v154, v60, v61 offset0:0 offset1:68
    v_pk_fma_f16 v121, v121, v125, v129 op_sel:[1,1,0] op_sel_hi:[1,0,1] neg_lo:[0,1,0]
    v_pk_mul_f16 v130, v122, v126 op_sel:[0,0] op_sel_hi:[0,1]
    v_pk_mul_f16 v131, v123, v127 op_sel:[0,0] op_sel_hi:[0,1]
    ds_write2_b32 v154, v62, v63 offset0:136 offset1:204
    v_pk_fma_f16 v122, v122, v126, v130 op_sel:[1,1,0] op_sel_hi:[1,0,1] neg_lo:[0,1,0]
    v_pk_fma_f16 v123, v123, v127, v131 op_sel:[1,1,0] op_sel_hi:[1,0,1] neg_lo:[0,1,0]
    ds_write2_b32 v155, v132, v133 offset0:0 offset1:68
    ds_write2_b32 v155, v134, v135 offset0:136 offset1:204
    s_setprio 3
    s_nop 0
    v_mfma_f32_16x16x32_f16 v[16:19], v[104:107], v[96:99], v[16:19]
    v_mfma_f32_16x16x32_f16 v[20:23], v[112:115], v[96:99], v[20:23]
    v_mfma_f32_16x16x32_f16 v[24:27], v[120:123], v[96:99], v[24:27]
    s_setprio 0
    s_nop 0
    ds_read_b128 v[64:67], v156 offset:0
    ds_read_b128 v[68:71], v157 offset:0
    ds_read_b128 v[72:75], v158 offset:0
    ds_read_b128 v[76:79], v159 offset:0
    ds_read_b128 v[80:83], v160 offset:0
    ds_read_b128 v[84:87], v161 offset:0
    ds_read_b128 v[88:91], v162 offset:0
    ds_read_b128 v[92:95], v163 offset:0
    ds_read_b128 v[96:99], v156 offset:64
    ds_read_b128 v[100:103], v157 offset:64
    ds_read_b128 v[104:107], v158 offset:64
    ds_read_b128 v[108:111], v159 offset:64
    ds_read_b128 v[112:115], v160 offset:64
    ds_read_b128 v[116:119], v161 offset:64
    ds_read_b128 v[120:123], v162 offset:64
    ds_read_b128 v[124:127], v163 offset:64
    s_waitcnt lgkmcnt(8)
    s_nop 0
    v_pk_mul_f16 v128, v64, v68 op_sel:[0,0] op_sel_hi:[0,1]
    v_pk_mul_f16 v129, v65, v69 op_sel:[0,0] op_sel_hi:[0,1]
    v_pk_fma_f16 v64, v64, v68, v128 op_sel:[1,1,0] op_sel_hi:[1,0,1] neg_lo:[0,1,0]
    v_pk_fma_f16 v65, v65, v69, v129 op_sel:[1,1,0] op_sel_hi:[1,0,1] neg_lo:[0,1,0]
    v_pk_mul_f16 v130, v66, v70 op_sel:[0,0] op_sel_hi:[0,1]
    v_pk_mul_f16 v131, v67, v71 op_sel:[0,0] op_sel_hi:[0,1]
    v_pk_fma_f16 v66, v66, v70, v130 op_sel:[1,1,0] op_sel_hi:[1,0,1] neg_lo:[0,1,0]
    v_pk_fma_f16 v67, v67, v71, v131 op_sel:[1,1,0] op_sel_hi:[1,0,1] neg_lo:[0,1,0]
    v_pk_mul_f16 v128, v72, v76 op_sel:[0,0] op_sel_hi:[0,1]
    v_pk_mul_f16 v129, v73, v77 op_sel:[0,0] op_sel_hi:[0,1]
    v_pk_fma_f16 v72, v72, v76, v128 op_sel:[1,1,0] op_sel_hi:[1,0,1] neg_lo:[0,1,0]
    v_pk_fma_f16 v73, v73, v77, v129 op_sel:[1,1,0] op_sel_hi:[1,0,1] neg_lo:[0,1,0]
    v_pk_mul_f16 v130, v74, v78 op_sel:[0,0] op_sel_hi:[0,1]
    v_pk_mul_f16 v131, v75, v79 op_sel:[0,0] op_sel_hi:[0,1]
    v_pk_fma_f16 v74, v74, v78, v130 op_sel:[1,1,0] op_sel_hi:[1,0,1] neg_lo:[0,1,0]
    v_pk_fma_f16 v75, v75, v79, v131 op_sel:[1,1,0] op_sel_hi:[1,0,1] neg_lo:[0,1,0]
    v_pk_mul_f16 v128, v80, v84 op_sel:[0,0] op_sel_hi:[0,1]
    v_pk_mul_f16 v129, v81, v85 op_sel:[0,0] op_sel_hi:[0,1]
    v_pk_fma_f16 v80, v80, v84, v128 op_sel:[1,1,0] op_sel_hi:[1,0,1] neg_lo:[0,1,0]
    v_pk_fma_f16 v81, v81, v85, v129 op_sel:[1,1,0] op_sel_hi:[1,0,1] neg_lo:[0,1,0]
    v_pk_mul_f16 v130, v82, v86 op_sel:[0,0] op_sel_hi:[0,1]
    v_pk_mul_f16 v131, v83, v87 op_sel:[0,0] op_sel_hi:[0,1]
    v_pk_fma_f16 v82, v82, v86, v130 op_sel:[1,1,0] op_sel_hi:[1,0,1] neg_lo:[0,1,0]
    v_pk_fma_f16 v83, v83, v87, v131 op_sel:[1,1,0] op_sel_hi:[1,0,1] neg_lo:[0,1,0]
    v_pk_mul_f16 v128, v88, v92 op_sel:[0,0] op_sel_hi:[0,1]
    v_pk_mul_f16 v129, v89, v93 op_sel:[0,0] op_sel_hi:[0,1]
    v_pk_fma_f16 v88, v88, v92, v128 op_sel:[1,1,0] op_sel_hi:[1,0,1] neg_lo:[0,1,0]
    v_pk_fma_f16 v89, v89, v93, v129 op_sel:[1,1,0] op_sel_hi:[1,0,1] neg_lo:[0,1,0]
    v_pk_mul_f16 v130, v90, v94 op_sel:[0,0] op_sel_hi:[0,1]
    v_pk_mul_f16 v131, v91, v95 op_sel:[0,0] op_sel_hi:[0,1]
    v_pk_fma_f16 v90, v90, v94, v130 op_sel:[1,1,0] op_sel_hi:[1,0,1] neg_lo:[0,1,0]
    v_pk_fma_f16 v91, v91, v95, v131 op_sel:[1,1,0] op_sel_hi:[1,0,1] neg_lo:[0,1,0]
    s_setprio 3
    s_nop 0
    v_mfma_f32_16x16x32_f16 v[16:19], v[72:75], v[64:67], v[16:19]
    v_mfma_f32_16x16x32_f16 v[20:23], v[80:83], v[64:67], v[20:23]
    v_mfma_f32_16x16x32_f16 v[24:27], v[88:91], v[64:67], v[24:27]
    s_setprio 0
    s_nop 0
    ds_read_b128 v[64:67], v156 offset:128
    ds_read_b128 v[68:71], v157 offset:128
    ds_read_b128 v[72:75], v158 offset:128
    ds_read_b128 v[76:79], v159 offset:128
    ds_read_b128 v[80:83], v160 offset:128
    ds_read_b128 v[84:87], v161 offset:128
    ds_read_b128 v[88:91], v162 offset:128
    ds_read_b128 v[92:95], v163 offset:128
    s_waitcnt lgkmcnt(8)
    s_nop 0
    v_pk_mul_f16 v128, v96, v100 op_sel:[0,0] op_sel_hi:[0,1]
    v_pk_mul_f16 v129, v97, v101 op_sel:[0,0] op_sel_hi:[0,1]
    v_pk_fma_f16 v96, v96, v100, v128 op_sel:[1,1,0] op_sel_hi:[1,0,1] neg_lo:[0,1,0]
    v_pk_fma_f16 v97, v97, v101, v129 op_sel:[1,1,0] op_sel_hi:[1,0,1] neg_lo:[0,1,0]
    v_pk_mul_f16 v130, v98, v102 op_sel:[0,0] op_sel_hi:[0,1]
    v_pk_mul_f16 v131, v99, v103 op_sel:[0,0] op_sel_hi:[0,1]
    v_pk_fma_f16 v98, v98, v102, v130 op_sel:[1,1,0] op_sel_hi:[1,0,1] neg_lo:[0,1,0]
    v_pk_fma_f16 v99, v99, v103, v131 op_sel:[1,1,0] op_sel_hi:[1,0,1] neg_lo:[0,1,0]
    v_pk_mul_f16 v128, v104, v108 op_sel:[0,0] op_sel_hi:[0,1]
    v_pk_mul_f16 v129, v105, v109 op_sel:[0,0] op_sel_hi:[0,1]
    v_pk_fma_f16 v104, v104, v108, v128 op_sel:[1,1,0] op_sel_hi:[1,0,1] neg_lo:[0,1,0]
    v_pk_fma_f16 v105, v105, v109, v129 op_sel:[1,1,0] op_sel_hi:[1,0,1] neg_lo:[0,1,0]
    v_pk_mul_f16 v130, v106, v110 op_sel:[0,0] op_sel_hi:[0,1]
    v_pk_mul_f16 v131, v107, v111 op_sel:[0,0] op_sel_hi:[0,1]
    v_pk_fma_f16 v106, v106, v110, v130 op_sel:[1,1,0] op_sel_hi:[1,0,1] neg_lo:[0,1,0]
    v_pk_fma_f16 v107, v107, v111, v131 op_sel:[1,1,0] op_sel_hi:[1,0,1] neg_lo:[0,1,0]
    v_pk_mul_f16 v128, v112, v116 op_sel:[0,0] op_sel_hi:[0,1]
    v_pk_mul_f16 v129, v113, v117 op_sel:[0,0] op_sel_hi:[0,1]
    v_pk_fma_f16 v112, v112, v116, v128 op_sel:[1,1,0] op_sel_hi:[1,0,1] neg_lo:[0,1,0]
    v_pk_fma_f16 v113, v113, v117, v129 op_sel:[1,1,0] op_sel_hi:[1,0,1] neg_lo:[0,1,0]
    v_pk_mul_f16 v130, v114, v118 op_sel:[0,0] op_sel_hi:[0,1]
    v_pk_mul_f16 v131, v115, v119 op_sel:[0,0] op_sel_hi:[0,1]
    v_pk_fma_f16 v114, v114, v118, v130 op_sel:[1,1,0] op_sel_hi:[1,0,1] neg_lo:[0,1,0]
    v_pk_fma_f16 v115, v115, v119, v131 op_sel:[1,1,0] op_sel_hi:[1,0,1] neg_lo:[0,1,0]
    v_pk_mul_f16 v128, v120, v124 op_sel:[0,0] op_sel_hi:[0,1]
    v_pk_mul_f16 v129, v121, v125 op_sel:[0,0] op_sel_hi:[0,1]
    v_pk_fma_f16 v120, v120, v124, v128 op_sel:[1,1,0] op_sel_hi:[1,0,1] neg_lo:[0,1,0]
    v_pk_fma_f16 v121, v121, v125, v129 op_sel:[1,1,0] op_sel_hi:[1,0,1] neg_lo:[0,1,0]
    v_pk_mul_f16 v130, v122, v126 op_sel:[0,0] op_sel_hi:[0,1]
    v_pk_mul_f16 v131, v123, v127 op_sel:[0,0] op_sel_hi:[0,1]
    v_pk_fma_f16 v122, v122, v126, v130 op_sel:[1,1,0] op_sel_hi:[1,0,1] neg_lo:[0,1,0]
    v_pk_fma_f16 v123, v123, v127, v131 op_sel:[1,1,0] op_sel_hi:[1,0,1] neg_lo:[0,1,0]
    s_setprio 3
    s_nop 0
    v_mfma_f32_16x16x32_f16 v[16:19], v[104:107], v[96:99], v[16:19]
    v_mfma_f32_16x16x32_f16 v[20:23], v[112:115], v[96:99], v[20:23]
    v_mfma_f32_16x16x32_f16 v[24:27], v[120:123], v[96:99], v[24:27]
    s_setprio 0
    s_nop 0
    ds_read_b128 v[96:99], v156 offset:192
    ds_read_b128 v[100:103], v157 offset:192
    ds_read_b128 v[104:107], v158 offset:192
    ds_read_b128 v[108:111], v159 offset:192
    ds_read_b128 v[112:115], v160 offset:192
    ds_read_b128 v[116:119], v161 offset:192
    ds_read_b128 v[120:123], v162 offset:192
    ds_read_b128 v[124:127], v163 offset:192
    s_waitcnt lgkmcnt(8)
    s_nop 0
    v_pk_mul_f16 v128, v64, v68 op_sel:[0,0] op_sel_hi:[0,1]
    v_pk_mul_f16 v129, v65, v69 op_sel:[0,0] op_sel_hi:[0,1]
    v_pk_fma_f16 v64, v64, v68, v128 op_sel:[1,1,0] op_sel_hi:[1,0,1] neg_lo:[0,1,0]
    v_pk_fma_f16 v65, v65, v69, v129 op_sel:[1,1,0] op_sel_hi:[1,0,1] neg_lo:[0,1,0]
    v_pk_mul_f16 v130, v66, v70 op_sel:[0,0] op_sel_hi:[0,1]
    v_pk_mul_f16 v131, v67, v71 op_sel:[0,0] op_sel_hi:[0,1]
    v_pk_fma_f16 v66, v66, v70, v130 op_sel:[1,1,0] op_sel_hi:[1,0,1] neg_lo:[0,1,0]
    v_pk_fma_f16 v67, v67, v71, v131 op_sel:[1,1,0] op_sel_hi:[1,0,1] neg_lo:[0,1,0]
    v_pk_mul_f16 v128, v72, v76 op_sel:[0,0] op_sel_hi:[0,1]
    v_pk_mul_f16 v129, v73, v77 op_sel:[0,0] op_sel_hi:[0,1]
    v_pk_fma_f16 v72, v72, v76, v128 op_sel:[1,1,0] op_sel_hi:[1,0,1] neg_lo:[0,1,0]
    v_pk_fma_f16 v73, v73, v77, v129 op_sel:[1,1,0] op_sel_hi:[1,0,1] neg_lo:[0,1,0]
    v_pk_mul_f16 v130, v74, v78 op_sel:[0,0] op_sel_hi:[0,1]
    v_pk_mul_f16 v131, v75, v79 op_sel:[0,0] op_sel_hi:[0,1]
    v_pk_fma_f16 v74, v74, v78, v130 op_sel:[1,1,0] op_sel_hi:[1,0,1] neg_lo:[0,1,0]
    v_pk_fma_f16 v75, v75, v79, v131 op_sel:[1,1,0] op_sel_hi:[1,0,1] neg_lo:[0,1,0]
    v_pk_mul_f16 v128, v80, v84 op_sel:[0,0] op_sel_hi:[0,1]
    v_pk_mul_f16 v129, v81, v85 op_sel:[0,0] op_sel_hi:[0,1]
    v_pk_fma_f16 v80, v80, v84, v128 op_sel:[1,1,0] op_sel_hi:[1,0,1] neg_lo:[0,1,0]
    v_pk_fma_f16 v81, v81, v85, v129 op_sel:[1,1,0] op_sel_hi:[1,0,1] neg_lo:[0,1,0]
    v_pk_mul_f16 v130, v82, v86 op_sel:[0,0] op_sel_hi:[0,1]
    v_pk_mul_f16 v131, v83, v87 op_sel:[0,0] op_sel_hi:[0,1]
    v_pk_fma_f16 v82, v82, v86, v130 op_sel:[1,1,0] op_sel_hi:[1,0,1] neg_lo:[0,1,0]
    v_pk_fma_f16 v83, v83, v87, v131 op_sel:[1,1,0] op_sel_hi:[1,0,1] neg_lo:[0,1,0]
    v_pk_mul_f16 v128, v88, v92 op_sel:[0,0] op_sel_hi:[0,1]
    v_pk_mul_f16 v129, v89, v93 op_sel:[0,0] op_sel_hi:[0,1]
    v_pk_fma_f16 v88, v88, v92, v128 op_sel:[1,1,0] op_sel_hi:[1,0,1] neg_lo:[0,1,0]
    v_pk_fma_f16 v89, v89, v93, v129 op_sel:[1,1,0] op_sel_hi:[1,0,1] neg_lo:[0,1,0]
    v_pk_mul_f16 v130, v90, v94 op_sel:[0,0] op_sel_hi:[0,1]
    v_pk_mul_f16 v131, v91, v95 op_sel:[0,0] op_sel_hi:[0,1]
    v_pk_fma_f16 v90, v90, v94, v130 op_sel:[1,1,0] op_sel_hi:[1,0,1] neg_lo:[0,1,0]
    v_pk_fma_f16 v91, v91, v95, v131 op_sel:[1,1,0] op_sel_hi:[1,0,1] neg_lo:[0,1,0]
    s_setprio 3
    s_nop 0
    v_mfma_f32_16x16x32_f16 v[16:19], v[72:75], v[64:67], v[16:19]
    v_mfma_f32_16x16x32_f16 v[20:23], v[80:83], v[64:67], v[20:23]
    v_mfma_f32_16x16x32_f16 v[24:27], v[88:91], v[64:67], v[24:27]
    s_setprio 0
    s_waitcnt lgkmcnt(0)
    v_pk_mul_f16 v128, v96, v100 op_sel:[0,0] op_sel_hi:[0,1]
    v_pk_mul_f16 v129, v97, v101 op_sel:[0,0] op_sel_hi:[0,1]
    v_pk_fma_f16 v96, v96, v100, v128 op_sel:[1,1,0] op_sel_hi:[1,0,1] neg_lo:[0,1,0]
    v_pk_fma_f16 v97, v97, v101, v129 op_sel:[1,1,0] op_sel_hi:[1,0,1] neg_lo:[0,1,0]
    v_pk_mul_f16 v130, v98, v102 op_sel:[0,0] op_sel_hi:[0,1]
    v_pk_mul_f16 v131, v99, v103 op_sel:[0,0] op_sel_hi:[0,1]
    v_pk_fma_f16 v98, v98, v102, v130 op_sel:[1,1,0] op_sel_hi:[1,0,1] neg_lo:[0,1,0]
    v_pk_fma_f16 v99, v99, v103, v131 op_sel:[1,1,0] op_sel_hi:[1,0,1] neg_lo:[0,1,0]
    v_pk_mul_f16 v128, v104, v108 op_sel:[0,0] op_sel_hi:[0,1]
    v_pk_mul_f16 v129, v105, v109 op_sel:[0,0] op_sel_hi:[0,1]
    v_pk_fma_f16 v104, v104, v108, v128 op_sel:[1,1,0] op_sel_hi:[1,0,1] neg_lo:[0,1,0]
    v_pk_fma_f16 v105, v105, v109, v129 op_sel:[1,1,0] op_sel_hi:[1,0,1] neg_lo:[0,1,0]
    v_pk_mul_f16 v130, v106, v110 op_sel:[0,0] op_sel_hi:[0,1]
    v_pk_mul_f16 v131, v107, v111 op_sel:[0,0] op_sel_hi:[0,1]
    v_pk_fma_f16 v106, v106, v110, v130 op_sel:[1,1,0] op_sel_hi:[1,0,1] neg_lo:[0,1,0]
    v_pk_fma_f16 v107, v107, v111, v131 op_sel:[1,1,0] op_sel_hi:[1,0,1] neg_lo:[0,1,0]
    v_pk_mul_f16 v128, v112, v116 op_sel:[0,0] op_sel_hi:[0,1]
    v_pk_mul_f16 v129, v113, v117 op_sel:[0,0] op_sel_hi:[0,1]
    v_pk_fma_f16 v112, v112, v116, v128 op_sel:[1,1,0] op_sel_hi:[1,0,1] neg_lo:[0,1,0]
    v_pk_fma_f16 v113, v113, v117, v129 op_sel:[1,1,0] op_sel_hi:[1,0,1] neg_lo:[0,1,0]
    v_pk_mul_f16 v130, v114, v118 op_sel:[0,0] op_sel_hi:[0,1]
    v_pk_mul_f16 v131, v115, v119 op_sel:[0,0] op_sel_hi:[0,1]
    v_pk_fma_f16 v114, v114, v118, v130 op_sel:[1,1,0] op_sel_hi:[1,0,1] neg_lo:[0,1,0]
    v_pk_fma_f16 v115, v115, v119, v131 op_sel:[1,1,0] op_sel_hi:[1,0,1] neg_lo:[0,1,0]
    v_pk_mul_f16 v128, v120, v124 op_sel:[0,0] op_sel_hi:[0,1]
    v_pk_mul_f16 v129, v121, v125 op_sel:[0,0] op_sel_hi:[0,1]
    v_pk_fma_f16 v120, v120, v124, v128 op_sel:[1,1,0] op_sel_hi:[1,0,1] neg_lo:[0,1,0]
    v_pk_fma_f16 v121, v121, v125, v129 op_sel:[1,1,0] op_sel_hi:[1,0,1] neg_lo:[0,1,0]
    v_pk_mul_f16 v130, v122, v126 op_sel:[0,0] op_sel_hi:[0,1]
    v_pk_mul_f16 v131, v123, v127 op_sel:[0,0] op_sel_hi:[0,1]
    v_pk_fma_f16 v122, v122, v126, v130 op_sel:[1,1,0] op_sel_hi:[1,0,1] neg_lo:[0,1,0]
    v_pk_fma_f16 v123, v123, v127, v131 op_sel:[1,1,0] op_sel_hi:[1,0,1] neg_lo:[0,1,0]
    s_setprio 3
    s_nop 0
    v_mfma_f32_16x16x32_f16 v[16:19], v[104:107], v[96:99], v[16:19]
    v_mfma_f32_16x16x32_f16 v[20:23], v[112:115], v[96:99], v[20:23]
    v_mfma_f32_16x16x32_f16 v[24:27], v[120:123], v[96:99], v[24:27]
    s_setprio 0
    v_cmp_eq_u32 vcc, 0, v0
    s_nop 1
    v_cndmask_b32 v14, 0, v14, vcc
    v_lshlrev_b32 v30, 4, v0
    v_lshlrev_b32 v31, 3, v0
    v_fma_f32 v16, v16, v15, v14
    v_mul_f32 v17, v17, v15
    v_mul_f32 v18, v18, v15
    v_mul_f32 v19, v19, v15
    v_mul_f32 v20, v20, v15
    v_mul_f32 v21, v21, v15
    v_mul_f32 v22, v22, v15
    v_mul_f32 v23, v23, v15
    v_mul_f32 v24, v24, v15
    v_mul_f32 v25, v25, v15
    v_mul_f32 v26, v26, v15
    v_mul_f32_e64 v27, v27, v15
    v_cvt_pk_bf16_f32 v32, v16, v17
    v_cvt_pk_bf16_f32 v33, v18, v19
    v_cvt_pk_bf16_f32 v34, v20, v21
    v_cvt_pk_bf16_f32 v35, v22, v23
    v_cvt_pk_bf16_f32 v36, v24, v25
    v_cvt_pk_bf16_f32 v37, v26, v27
    buffer_store_dwordx4 v[32:35], v30, s[16:19], s76 offen sc1
    buffer_store_dwordx2 v[36:37], v31, s[16:19], s76 offen offset:1024 sc1
L1end:
    s_endpgm
.section .rodata,"a"
.p2align 6
.amdhsa_kernel k1_kernel
  .amdhsa_next_free_vgpr 168
  .amdhsa_next_free_sgpr 102
  .amdhsa_accum_offset 168
  .amdhsa_group_segment_fixed_size 0
  .amdhsa_kernarg_size 112
  .amdhsa_user_sgpr_count 2
  .amdhsa_user_sgpr_kernarg_segment_ptr 1
  .amdhsa_system_sgpr_workgroup_id_x 1
.end_amdhsa_kernel
.text
.globl k2_kernel
.p2align 8
.type k2_kernel,@function
k2_kernel:
    s_cmp_ge_u32 s2, 256
    s_cbranch_scc1 L2end
    s_nop 0
    s_load_dwordx2 s[32:33], s[0:1], 0
    s_load_dwordx2 s[34:35], s[0:1], 88
    s_load_dwordx2 s[58:59], s[0:1], 104
    v_lshrrev_b32 v1, 6, v0
    v_and_b32 v0, 63, v0
    v_readfirstlane_b32 s3, v1
    s_and_b32 s60, s2, 3
    s_bfe_u32 s61, s2, 0x10002
    s_bfe_u32 s62, s2, 0x30003
    s_lshr_b32 s63, s2, 6
    s_lshl_b32 s4, s60, 3
    s_add_u32 s4, s4, s62
    s_lshl_b32 s5, s61, 2
    s_add_u32 s5, s5, s63
    v_lshlrev_b32 v1, 4, v0
    s_mov_b32 s96, 0
    s_cmp_ge_u32 s3, 4
    s_cbranch_scc1 L2g2
    s_setprio 0
    s_and_b32 s6, s2, 1
    s_lshr_b32 s7, s2, 1
    s_mul_i32 s7, s7, 5
    s_mul_i32 s64, s6, 3
    s_add_u32 s7, s7, s64
    s_sub_u32 s64, 3, s6
    s_sub_u32 s65, s3, s64
    s_cmp_lt_u32 s3, s64
    s_cselect_b32 s65, s3, s65
    s_cselect_b32 s66, 1, 0
    s_add_u32 s7, s7, s65
    s_mul_i32 s67, s65, 14720
    s_add_u32 s67, s67, 256
    s_cmp_eq_u32 s6, 0
    s_cselect_b32 s68, 3, 1
    s_lshl_b32 s69, s7, 12
    s_add_u32 s70, s69, 1048576
    s_add_u32 s71, s69, 20971520
    s_lshl_b32 s72, s7, 11
    s_add_u32 s72, s72, 4194304
    v_lshlrev_b32 v2, 3, v0
    s_waitcnt lgkmcnt(0)
    s_mov_b32 s16, s58
    s_mov_b32 s17, s59
    s_mov_b32 s18, 268435456
    s_mov_b32 s19, 0x20000
    s_cmp_eq_u32 s6, 0
    s_cselect_b32 s76, 7, 4
    s_cselect_b32 s77, 1, 4
    s_lshl_b32 s75, s76, 6
    s_mov_b32 s78, 0
    s_lshl_b32 s73, s65, 2
    s_lshl_b32 s48, s65, 13
    s_add_u32 s48, s48, 44416
    s_cmp_eq_u32 s66, 0
    s_cbranch_scc1 L2v2
    buffer_load_dwordx4 v[170:173], v1, s[16:19], s72 offen
    buffer_load_dwordx2 v[174:175], v2, s[16:19], s72 offen offset:1024
    s_add_u32 m0, s67, 512
    s_add_u32 s72, s72, 2048
    buffer_load_dwordx4 v1, s[16:19], s70 offen offset:0 lds
    buffer_load_dwordx4 v1, s[16:19], s70 offen offset:1024 lds
    buffer_load_dwordx4 v1, s[16:19], s70 offen offset:2048 lds
    buffer_load_dwordx4 v1, s[16:19], s70 offen offset:3072 lds
    s_add_u32 s70, s70, 4096
    s_barrier
    v_and_b32 v3, 15, v0
    v_lshrrev_b32 v4, 4, v0
    v_lshrrev_b32 v5, 1, v4
    v_and_b32 v6, 1, v4
    v_lshlrev_b32 v100, 8, v5
    v_lshl_add_u32 v100, v3, 4, v100
    v_lshl_add_u32 v100, v6, 3, v100
    v_add_u32 v100, 13184, v100
    v_lshlrev_b32 v7, 7, v6
    v_lshl_add_u32 v101, v3, 3, v7
    v_add_u32 v101, 13696, v101
    v_add_u32 v102, 4, v101
    v_lshl_add_u32 v8, v3, 2, v7
    v_add_u32 v8, 13952, v8
    v_add_u32 v9, 64, v8
    v_cmp_lt_u32 vcc, 31, v0
    s_nop 1
    v_cndmask_b32 v101, v101, v8, vcc
    v_cndmask_b32 v102, v102, v9, vcc
    v_lshlrev_b32 v103, 7, v4
    v_lshl_add_u32 v103, v3, 1, v103
    v_add_u32 v103, 14208, v103
    v_lshlrev_b32 v104, 2, v0
    v_add_u32 v104, 13184, v104
    v_add_u32 v105, 13184, v2
    v_lshlrev_b32 v8, 5, v0
    v_sub_u32 v106, 6880, v8
    v_sub_u32 v107, 7920, v1
    v_sub_u32 v108, 8440, v2
    v_sub_u32 v109, 8952, v2
    v_and_b32_e64 v8, 7, v0
    v_bfe_u32 v9, v0, 3, 1
    v_mul_u32_u24 v9, 4160, v9
    v_lshl_add_u32 v120, v8, 2, v9
    v_add_u32 v120, 8960, v120
    v_cmp_eq_u32 s[46:47], 0, v3
    v_mov_b32 v122, v2
    v_mov_b32 v124, 0
    v_mov_b32_e64 v125, 0
    s_mov_b32 s40, 0x01000100
    s_mov_b32 s41, 0x03020302
    s_mov_b32 s42, 0x01000302
    s_mov_b32 s43, 0x03020504
    v_and_b32 v8, 1, v3
    v_add_u32 v9, v3, v8
    v_mul_u32_u24 v8, 4160, v8
    v_lshlrev_b32 v10, 3, v4
    v_sub_u32 v10, v10, v9
    v_lshl_add_u32 v10, v10, 1, v8
    v_add_u32 v150, 8416, v10
    v_add_u32 v151, 7392, v10
    v_add_u32 v152, 6368, v10
    v_add_u32 v153, 5344, v10
    v_lshl_add_u32 v10, v3, 1, v4
    v_lshlrev_b32 v10, 4, v10
    v_add_u32 v154, 480, v10
    v_lshlrev_b32 v160, 5, v3
    v_lshl_add_u32 v161, v4, 3, v160
    v_lshl_add_u32 v160, v5, 4, v160
    v_xor_b32 v6, 1, v6
    v_lshl_add_u32 v160, v6, 9, v160
    s_waitcnt vmcnt(4)
    v_add_u32 v110, s67, v100
    v_add_u32 v111, s67, v101
    v_add_u32 v112, s67, v102
    v_add_u32 v113, s67, v103
    v_add_u32 v114, s67, v104
    v_add_u32 v115, s67, v105
    v_add_u32 v116, s67, v106
    v_add_u32 v117, s67, v107
    v_add_u32 v118, s67, v108
    v_add_u32 v119, s67, v109
    ds_write_b64 v110, v[170:171]
    ds_write_b32 v111, v172
    ds_write_b32 v112, v173
    ds_write_b16 v113, v174
    ds_write_b16_d16_hi v113, v174 offset:32
    ds_write_b16 v113, v175 offset:64
    ds_write_b16_d16_hi v113, v175 offset:96
    s_waitcnt lgkmcnt(0)
    s_nop 0
    ds_read2_b32 v[8:9], v115 offset0:0 offset1:1
    ds_read_b32 v10, v115 offset:8
    ds_read2_b32 v[12:13], v114 offset0:128 offset1:129
    ds_read2_b32 v[14:15], v114 offset0:192 offset1:193
    ds_read_b32 v16, v114 offset:1024
    ds_read_b32 v17, v114 offset:1028
    s_waitcnt lgkmcnt(0)
    s_nop 0
    v_perm_b32 v20, v9, v9, s42
    v_perm_b32 v21, v8, v8, s42
    v_perm_b32 v22, v10, v9, s43
    v_perm_b32 v23, v9, v8, s43
    ds_write_b64 v119, v[20:21] offset:4160
    ds_write_b64 v119, v[22:23]
    v_perm_b32 v24, v13, v12, s43
    v_perm_b32 v25, v12, v12, s40
    v_perm_b32 v26, v13, v13, s40
    v_perm_b32 v27, v12, v12, s42
    ds_write_b64 v118, v[24:25] offset:4160
    ds_write_b64 v118, v[26:27]
    v_perm_b32 v28, v15, v15, s40
    v_perm_b32 v29, v14, v14, s41
    v_perm_b32 v30, v14, v14, s42
    v_perm_b32 v31, v14, v14, s40
    v_perm_b32 v32, v15, v15, s40
    v_perm_b32 v33, v15, v14, s43
    v_perm_b32 v34, v14, v14, s41
    v_perm_b32 v35, v14, v14, s40
    ds_write_b128 v117, v[28:31] offset:4160
    ds_write_b128 v117, v[32:35]
    v_perm_b32 v36, v17, v17, s40
    v_perm_b32 v37, v17, v17, s40
    v_perm_b32 v38, v16, v16, s41
    v_perm_b32 v39, v16, v16, s41
    v_perm_b32 v40, v16, v16, s41
    v_perm_b32 v41, v16, v16, s42
    v_perm_b32 v42, v16, v16, s40
    v_perm_b32 v43, v16, v16, s40
    ds_write_b128 v116, v[36:39] offset:4160
    ds_write_b128 v116, v[40:43] offset:4176
    v_perm_b32 v44, v17, v17, s40
    v_perm_b32 v45, v17, v17, s40
    v_perm_b32 v46, v17, v16, s43
    v_perm_b32 v47, v16, v16, s41
    v_perm_b32 v48, v16, v16, s41
    v_perm_b32 v49, v16, v16, s41
    v_perm_b32 v50, v16, v16, s40
    v_perm_b32 v51, v16, v16, s40
    ds_write_b128 v116, v[44:47]
    ds_write_b128 v116, v[48:51] offset:16
    v_add_u32 v121, s67, v120
    v_readfirstlane_b32 s44, v8
    s_nop 0
    s_and_b32 s44, s44, 0xffff
    v_mov_b32 v52, s44
    v_cndmask_b32 v52, 0, v52, s[46:47]
    ds_write_b32 v121, v52
    v_add_u32 v121, s67, v122
    ds_write_b64 v121, v[124:125]
    s_waitcnt vmcnt(0) lgkmcnt(0)
    v_mov_b32 v8, s73
    v_mov_b32 v9, 1
    ds_write_b32 v8, v9 offset:0
    s_sub_u32 s44, s67, s78
    v_add_u32 v140, s44, v150
    v_add_u32 v141, s44, v151
    v_add_u32 v142, s44, v152
    v_add_u32 v143, s44, v153
    v_add_u32 v144, s44, v154
    ds_read2_b32 v[8:9], v140 offset0:128 offset1:129
    ds_read2_b32 v[10:11], v140 offset0:130 offset1:131
    ds_read_b128 v[40:43], v144 offset:0
    ds_read2_b32 v[12:13], v140 offset0:0 offset1:1
    ds_read2_b32 v[14:15], v140 offset0:2 offset1:3
    ds_read_b128 v[44:47], v144 offset:512
    ds_read2_b32 v[16:17], v141 offset0:128 offset1:129
    ds_read2_b32 v[18:19], v141 offset0:130 offset1:131
    ds_read_b128 v[48:51], v144 offset:1024
    ds_read2_b32 v[20:21], v141 offset0:0 offset1:1
    ds_read2_b32 v[22:23], v141 offset0:2 offset1:3
    ds_read_b128 v[52:55], v144 offset:1536
    ds_read2_b32 v[24:25], v142 offset0:128 offset1:129
    ds_read2_b32 v[26:27], v142 offset0:130 offset1:131
    ds_read_b128 v[56:59], v144 offset:2048
    ds_read2_b32 v[28:29], v142 offset0:0 offset1:1
    ds_read2_b32 v[30:31], v142 offset0:2 offset1:3
    ds_read_b128 v[60:63], v144 offset:2560
    ds_read2_b32 v[32:33], v143 offset0:128 offset1:129
    ds_read2_b32 v[34:35], v143 offset0:130 offset1:131
    ds_read_b128 v[64:67], v144 offset:3072
    ds_read2_b32 v[36:37], v143 offset0:0 offset1:1
    ds_read2_b32 v[38:39], v143 offset0:2 offset1:3
    ds_read_b128 v[68:71], v144 offset:3584
    v_subrev_u32 v140, 64, v140
    v_subrev_u32 v141, 64, v141
    v_subrev_u32 v142, 64, v142
    v_subrev_u32 v143, 64, v143
    v_subrev_u32 v144, 64, v144
    v_mov_b32 v200, 0
    v_mov_b32 v201, 0
    v_mov_b32 v202, 0
    v_mov_b32 v203, 0
    v_mov_b32 v204, 0
    v_mov_b32 v205, 0
    v_mov_b32 v206, 0
    v_mov_b32 v207, 0
    v_mov_b32 v208, 0
    v_mov_b32 v209, 0
    v_mov_b32 v210, 0
    v_mov_b32 v211, 0
    v_mov_b32 v212, 0
    v_mov_b32 v213, 0
    v_mov_b32 v214, 0
    v_mov_b32 v215, 0
    v_mov_b32 v216, 0
    v_mov_b32 v217, 0
    v_mov_b32 v218, 0
    v_mov_b32 v219, 0
    v_mov_b32 v220, 0
    v_mov_b32 v221, 0
    v_mov_b32 v222, 0
    v_mov_b32 v223, 0
    v_mov_b32 v224, 0
    v_mov_b32 v225, 0
    v_mov_b32 v226, 0
    v_mov_b32 v227, 0
    v_mov_b32 v228, 0
    v_mov_b32 v229, 0
    v_mov_b32 v230, 0
    v_mov_b32_e64 v231, 0
    s_mov_b32 s45, 0
L2v1loop:
    s_waitcnt lgkmcnt(0)
    v_mfma_f32_16x16x32_bf16 v[200:203], v[8:11], v[68:71], v[200:203]
    ds_read2_b32 v[72:73], v140 offset0:128 offset1:129
    v_mfma_f32_16x16x32_bf16 v[200:203], v[12:15], v[64:67], v[200:203]
    ds_read2_b32 v[74:75], v140 offset0:130 offset1:131
    v_mfma_f32_16x16x32_bf16 v[200:203], v[16:19], v[60:63], v[200:203]
    ds_read_b128 v[104:107], v144 offset:0
    v_mfma_f32_16x16x32_bf16 v[200:203], v[20:23], v[56:59], v[200:203]
    ds_read2_b32 v[76:77], v140 offset0:0 offset1:1
    v_mfma_f32_16x16x32_bf16 v[200:203], v[24:27], v[52:55], v[200:203]
    ds_read2_b32 v[78:79], v140 offset0:2 offset1:3
    v_mfma_f32_16x16x32_bf16 v[200:203], v[28:31], v[48:51], v[200:203]
    ds_read_b128 v[108:111], v144 offset:512
    v_mfma_f32_16x16x32_bf16 v[200:203], v[32:35], v[44:47], v[200:203]
    ds_read2_b32 v[80:81], v141 offset0:128 offset1:129
    v_mfma_f32_16x16x32_bf16 v[200:203], v[36:39], v[40:43], v[200:203]
    ds_read2_b32 v[82:83], v141 offset0:130 offset1:131
    v_mfma_f32_16x16x32_bf16 v[204:207], v[8:11], v[64:67], v[204:207]
    ds_read_b128 v[112:115], v144 offset:1024
    v_mfma_f32_16x16x32_bf16 v[204:207], v[12:15], v[60:63], v[204:207]
    ds_read2_b32 v[84:85], v141 offset0:0 offset1:1
    v_mfma_f32_16x16x32_bf16 v[204:207], v[16:19], v[56:59], v[204:207]
    ds_read2_b32 v[86:87], v141 offset0:2 offset1:3
    v_mfma_f32_16x16x32_bf16 v[204:207], v[20:23], v[52:55], v[204:207]
    ds_read_b128 v[116:119], v144 offset:1536
    v_mfma_f32_16x16x32_bf16 v[204:207], v[24:27], v[48:51], v[204:207]
    ds_read2_b32 v[88:89], v142 offset0:128 offset1:129
    v_mfma_f32_16x16x32_bf16 v[204:207], v[28:31], v[44:47], v[204:207]
    ds_read2_b32 v[90:91], v142 offset0:130 offset1:131
    v_mfma_f32_16x16x32_bf16 v[204:207], v[32:35], v[40:43], v[204:207]
    ds_read_b128 v[120:123], v144 offset:2048
    v_mfma_f32_16x16x32_bf16 v[208:211], v[8:11], v[60:63], v[208:211]
    ds_read2_b32 v[92:93], v142 offset0:0 offset1:1
    v_mfma_f32_16x16x32_bf16 v[208:211], v[12:15], v[56:59], v[208:211]
    ds_read2_b32 v[94:95], v142 offset0:2 offset1:3
    v_mfma_f32_16x16x32_bf16 v[208:211], v[16:19], v[52:55], v[208:211]
    ds_read_b128 v[124:127], v144 offset:2560
    v_mfma_f32_16x16x32_bf16 v[208:211], v[20:23], v[48:51], v[208:211]
    ds_read2_b32 v[96:97], v143 offset0:128 offset1:129
    v_mfma_f32_16x16x32_bf16 v[208:211], v[24:27], v[44:47], v[208:211]
    ds_read2_b32 v[98:99], v143 offset0:130 offset1:131
    v_mfma_f32_16x16x32_bf16 v[208:211], v[28:31], v[40:43], v[208:211]
    ds_read_b128 v[128:131], v144 offset:3072
    v_mfma_f32_16x16x32_bf16 v[212:215], v[8:11], v[56:59], v[212:215]
    ds_read2_b32 v[100:101], v143 offset0:0 offset1:1
    v_mfma_f32_16x16x32_bf16 v[212:215], v[12:15], v[52:55], v[212:215]
    ds_read2_b32 v[102:103], v143 offset0:2 offset1:3
    v_mfma_f32_16x16x32_bf16 v[212:215], v[16:19], v[48:51], v[212:215]
    ds_read_b128 v[132:135], v144 offset:3584
    v_mfma_f32_16x16x32_bf16 v[212:215], v[20:23], v[44:47], v[212:215]
    v_subrev_u32 v140, 64, v140
    v_mfma_f32_16x16x32_bf16 v[212:215], v[24:27], v[40:43], v[212:215]
    v_subrev_u32 v141, 64, v141
    v_mfma_f32_16x16x32_bf16 v[216:219], v[8:11], v[52:55], v[216:219]
    v_subrev_u32 v142, 64, v142
    v_mfma_f32_16x16x32_bf16 v[216:219], v[12:15], v[48:51], v[216:219]
    v_subrev_u32 v143, 64, v143
    v_mfma_f32_16x16x32_bf16 v[216:219], v[16:19], v[44:47], v[216:219]
    v_subrev_u32 v144, 64, v144
    v_mfma_f32_16x16x32_bf16 v[216:219], v[20:23], v[40:43], v[216:219]
    s_add_u32 s45, s45, 1
    v_mfma_f32_16x16x32_bf16 v[220:223], v[8:11], v[48:51], v[220:223]
    s_cmp_lt_u32 s45, s76
    s_nop 0
    v_mfma_f32_16x16x32_bf16 v[220:223], v[12:15], v[44:47], v[220:223]
    v_mfma_f32_16x16x32_bf16 v[220:223], v[16:19], v[40:43], v[220:223]
    v_mfma_f32_16x16x32_bf16 v[224:227], v[8:11], v[44:47], v[224:227]
    v_mfma_f32_16x16x32_bf16 v[224:227], v[12:15], v[40:43], v[224:227]
    v_mfma_f32_16x16x32_bf16 v[228:231], v[8:11], v[40:43], v[228:231]
    s_cbranch_scc0 L2v1loopx
    s_waitcnt lgkmcnt(0)
    v_mfma_f32_16x16x32_bf16 v[200:203], v[72:75], v[132:135], v[200:203]
    ds_read2_b32 v[8:9], v140 offset0:128 offset1:129
    v_mfma_f32_16x16x32_bf16 v[200:203], v[76:79], v[128:131], v[200:203]
    ds_read2_b32 v[10:11], v140 offset0:130 offset1:131
    v_mfma_f32_16x16x32_bf16 v[200:203], v[80:83], v[124:127], v[200:203]
    ds_read_b128 v[40:43], v144 offset:0
    v_mfma_f32_16x16x32_bf16 v[200:203], v[84:87], v[120:123], v[200:203]
    ds_read2_b32 v[12:13], v140 offset0:0 offset1:1
    v_mfma_f32_16x16x32_bf16 v[200:203], v[88:91], v[116:119], v[200:203]
    ds_read2_b32 v[14:15], v140 offset0:2 offset1:3
    v_mfma_f32_16x16x32_bf16 v[200:203], v[92:95], v[112:115], v[200:203]
    ds_read_b128 v[44:47], v144 offset:512
    v_mfma_f32_16x16x32_bf16 v[200:203], v[96:99], v[108:111], v[200:203]
    ds_read2_b32 v[16:17], v141 offset0:128 offset1:129
    v_mfma_f32_16x16x32_bf16 v[200:203], v[100:103], v[104:107], v[200:203]
    ds_read2_b32 v[18:19], v141 offset0:130 offset1:131
    v_mfma_f32_16x16x32_bf16 v[204:207], v[72:75], v[128:131], v[204:207]
    ds_read_b128 v[48:51], v144 offset:1024
    v_mfma_f32_16x16x32_bf16 v[204:207], v[76:79], v[124:127], v[204:207]
    ds_read2_b32 v[20:21], v141 offset0:0 offset1:1
    v_mfma_f32_16x16x32_bf16 v[204:207], v[80:83], v[120:123], v[204:207]
    ds_read2_b32 v[22:23], v141 offset0:2 offset1:3
    v_mfma_f32_16x16x32_bf16 v[204:207], v[84:87], v[116:119], v[204:207]
    ds_read_b128 v[52:55], v144 offset:1536
    v_mfma_f32_16x16x32_bf16 v[204:207], v[88:91], v[112:115], v[204:207]
    ds_read2_b32 v[24:25], v142 offset0:128 offset1:129
    v_mfma_f32_16x16x32_bf16 v[204:207], v[92:95], v[108:111], v[204:207]
    ds_read2_b32 v[26:27], v142 offset0:130 offset1:131
    v_mfma_f32_16x16x32_bf16 v[204:207], v[96:99], v[104:107], v[204:207]
    ds_read_b128 v[56:59], v144 offset:2048
    v_mfma_f32_16x16x32_bf16 v[208:211], v[72:75], v[124:127], v[208:211]
    ds_read2_b32 v[28:29], v142 offset0:0 offset1:1
    v_mfma_f32_16x16x32_bf16 v[208:211], v[76:79], v[120:123], v[208:211]
    ds_read2_b32 v[30:31], v142 offset0:2 offset1:3
    v_mfma_f32_16x16x32_bf16 v[208:211], v[80:83], v[116:119], v[208:211]
    ds_read_b128 v[60:63], v144 offset:2560
    v_mfma_f32_16x16x32_bf16 v[208:211], v[84:87], v[112:115], v[208:211]
    ds_read2_b32 v[32:33], v143 offset0:128 offset1:129
    v_mfma_f32_16x16x32_bf16 v[208:211], v[88:91], v[108:111], v[208:211]
    ds_read2_b32 v[34:35], v143 offset0:130 offset1:131
    v_mfma_f32_16x16x32_bf16 v[208:211], v[92:95], v[104:107], v[208:211]
    ds_read_b128 v[64:67], v144 offset:3072
    v_mfma_f32_16x16x32_bf16 v[212:215], v[72:75], v[120:123], v[212:215]
    ds_read2_b32 v[36:37], v143 offset0:0 offset1:1
    v_mfma_f32_16x16x32_bf16 v[212:215], v[76:79], v[116:119], v[212:215]
    ds_read2_b32 v[38:39], v143 offset0:2 offset1:3
    v_mfma_f32_16x16x32_bf16 v[212:215], v[80:83], v[112:115], v[212:215]
    ds_read_b128 v[68:71], v144 offset:3584
    v_mfma_f32_16x16x32_bf16 v[212:215], v[84:87], v[108:111], v[212:215]
    v_subrev_u32 v140, 64, v140
    v_mfma_f32_16x16x32_bf16 v[212:215], v[88:91], v[104:107], v[212:215]
    v_subrev_u32 v141, 64, v141
    v_mfma_f32_16x16x32_bf16 v[216:219], v[72:75], v[116:119], v[216:219]
    v_subrev_u32 v142, 64, v142
    v_mfma_f32_16x16x32_bf16 v[216:219], v[76:79], v[112:115], v[216:219]
    v_subrev_u32 v143, 64, v143
    v_mfma_f32_16x16x32_bf16 v[216:219], v[80:83], v[108:111], v[216:219]
    v_subrev_u32 v144, 64, v144
    v_mfma_f32_16x16x32_bf16 v[216:219], v[84:87], v[104:107], v[216:219]
    s_add_u32 s45, s45, 1
    v_mfma_f32_16x16x32_bf16 v[220:223], v[72:75], v[112:115], v[220:223]
    s_cmp_lt_u32 s45, s76
    s_nop 0
    v_mfma_f32_16x16x32_bf16 v[220:223], v[76:79], v[108:111], v[220:223]
    v_mfma_f32_16x16x32_bf16 v[220:223], v[80:83], v[104:107], v[220:223]
    v_mfma_f32_16x16x32_bf16 v[224:227], v[72:75], v[108:111], v[224:227]
    v_mfma_f32_16x16x32_bf16 v[224:227], v[76:79], v[104:107], v[224:227]
    v_mfma_f32_16x16x32_bf16 v[228:231], v[72:75], v[104:107], v[228:231]
    s_cbranch_scc1 L2v1loop
L2v1loopx:
    s_nop 7
    s_waitcnt lgkmcnt(0)
    s_add_u32 s73, s73, 16
    v_add_u32 v10, s48, v1
    v_mov_b32 v8, s73
L2pf:
    ds_read_b32 v9, v8 offset:0
    s_waitcnt lgkmcnt(0)
    v_readfirstlane_b32 s74, v9
    s_nop 0
    s_cmp_eq_u32 s74, 1
    s_cbranch_scc1 L2pfok
    s_add_u32 s96, s96, 1
    s_cmp_gt_u32 s96, 0x80000
    s_cbranch_scc1 L2pfok
    s_sleep 1
    s_branch L2pf
L2pfok:
    s_nop 0
    ds_read_b128 v[16:19], v10 offset:0
    ds_read_b128 v[20:23], v10 offset:1024
    ds_read_b128 v[24:27], v10 offset:2048
    ds_read_b128 v[28:31], v10 offset:3072
    ds_read_b128 v[32:35], v10 offset:4096
    ds_read_b128 v[36:39], v10 offset:5120
    ds_read_b128 v[40:43], v10 offset:6144
    ds_read_b128 v[44:47], v10 offset:7168
    s_waitcnt lgkmcnt(7)
    v_add_f32 v200, v200, v16
    v_add_f32 v201, v201, v17
    v_add_f32 v202, v202, v18
    v_add_f32 v203, v203, v19
    s_waitcnt lgkmcnt(6)
    v_add_f32 v204, v204, v20
    v_add_f32 v205, v205, v21
    v_add_f32 v206, v206, v22
    v_add_f32 v207, v207, v23
    s_waitcnt lgkmcnt(5)
    v_add_f32 v208, v208, v24
    v_add_f32 v209, v209, v25
    v_add_f32 v210, v210, v26
    v_add_f32 v211, v211, v27
    s_waitcnt lgkmcnt(4)
    v_add_f32 v212, v212, v28
    v_add_f32 v213, v213, v29
    v_add_f32 v214, v214, v30
    v_add_f32 v215, v215, v31
    s_waitcnt lgkmcnt(3)
    v_add_f32 v216, v216, v32
    v_add_f32 v217, v217, v33
    v_add_f32 v218, v218, v34
    v_add_f32 v219, v219, v35
    s_waitcnt lgkmcnt(2)
    v_add_f32 v220, v220, v36
    v_add_f32 v221, v221, v37
    v_add_f32 v222, v222, v38
    v_add_f32 v223, v223, v39
    s_waitcnt lgkmcnt(1)
    v_add_f32 v224, v224, v40
    v_add_f32 v225, v225, v41
    v_add_f32 v226, v226, v42
    v_add_f32 v227, v227, v43
    s_waitcnt lgkmcnt(0)
    v_add_f32 v228, v228, v44
    v_add_f32 v229, v229, v45
    v_add_f32_e64 v230, v230, v46
    v_add_f32 v231, v231, v47
    s_setprio 3
    v_cvt_pk_bf16_f32 v64, v200, v201
    v_cvt_pk_bf16_f32 v65, v202, v203
    v_cvt_pk_bf16_f32 v66, v204, v205
    v_cvt_pk_bf16_f32 v67, v206, v207
    s_nop 0
    v_permlane16_swap_b32 v64, v66
    v_permlane16_swap_b32 v65, v67
    s_nop 0
    buffer_store_dwordx4 v[64:67], v160, s[16:19], s71 offen offset:3072 sc1
    v_cvt_pk_bf16_f32 v68, v208, v209
    v_cvt_pk_bf16_f32 v69, v210, v211
    v_cvt_pk_bf16_f32 v70, v212, v213
    v_cvt_pk_bf16_f32 v71, v214, v215
    s_nop 0
    v_permlane16_swap_b32 v68, v70
    v_permlane16_swap_b32 v69, v71
    s_nop 0
    buffer_store_dwordx4 v[68:71], v160, s[16:19], s71 offen offset:2048 sc1
    v_cvt_pk_bf16_f32 v72, v216, v217
    v_cvt_pk_bf16_f32 v73, v218, v219
    v_cvt_pk_bf16_f32 v74, v220, v221
    v_cvt_pk_bf16_f32 v75, v222, v223
    s_nop 0
    v_permlane16_swap_b32 v72, v74
    v_permlane16_swap_b32 v73, v75
    s_nop 0
    buffer_store_dwordx4 v[72:75], v160, s[16:19], s71 offen offset:1024 sc1
    v_cvt_pk_bf16_f32 v76, v224, v225
    v_cvt_pk_bf16_f32 v77, v226, v227
    v_cvt_pk_bf16_f32 v78, v228, v229
    v_cvt_pk_bf16_f32 v79, v230, v231
    s_nop 0
    v_permlane16_swap_b32 v76, v78
    v_permlane16_swap_b32 v77, v79
    buffer_store_dwordx4 v[76:79], v160, s[16:19], s71 offen offset:0 sc1
    s_branch L2cdone
L2v2:
    v_mov_b32 v8, 0
    v_lshlrev_b32 v9, 2, v0
    ds_write_b32 v9, v8 offset:0
    s_waitcnt lgkmcnt(0)
    s_barrier
    v_and_b32 v3, 15, v0
    v_lshrrev_b32 v4, 4, v0
    v_lshrrev_b32 v5, 1, v4
    v_and_b32 v6, 1, v4
    v_lshlrev_b32_e64 v100, 8, v5
    v_lshl_add_u32 v100, v3, 4, v100
    v_lshl_add_u32 v100, v6, 3, v100
    v_add_u32 v100, 13184, v100
    v_lshlrev_b32 v7, 7, v6
    v_lshl_add_u32 v101, v3, 3, v7
    v_add_u32 v101, 13696, v101
    v_add_u32 v102, 4, v101
    v_lshl_add_u32 v8, v3, 2, v7
    v_add_u32 v8, 13952, v8
    v_add_u32 v9, 64, v8
    v_cmp_lt_u32 vcc, 31, v0
    s_nop 1
    v_cndmask_b32 v101, v101, v8, vcc
    v_cndmask_b32 v102, v102, v9, vcc
    v_lshlrev_b32 v103, 7, v4
    v_lshl_add_u32 v103, v3, 1, v103
    v_add_u32 v103, 14208, v103
    v_lshlrev_b32 v104, 2, v0
    v_add_u32 v104, 13184, v104
    v_add_u32 v105, 13184, v2
    v_lshlrev_b32 v8, 5, v0
    v_sub_u32 v106, 6880, v8
    v_sub_u32 v107, 7920, v1
    v_sub_u32 v108, 8440, v2
    v_sub_u32 v109, 8952, v2
    v_and_b32_e64 v8, 7, v0
    v_bfe_u32 v9, v0, 3, 1
    v_mul_u32_u24 v9, 4160, v9
    v_lshl_add_u32 v120, v8, 2, v9
    v_add_u32 v120, 8960, v120
    v_cmp_eq_u32 s[46:47], 0, v3
    v_mov_b32 v122, v2
    v_mov_b32 v124, 0
    v_mov_b32_e64 v125, 0
    s_mov_b32 s40, 0x01000100
    s_mov_b32 s41, 0x03020302
    s_mov_b32 s42, 0x01000302
    s_mov_b32 s43, 0x03020504
    v_and_b32 v8, 1, v3
    v_add_u32 v9, v3, v8
    v_mul_u32_u24 v8, 4160, v8
    v_lshlrev_b32 v10, 3, v4
    v_sub_u32 v10, v10, v9
    v_lshl_add_u32 v10, v10, 1, v8
    v_add_u32 v150, 8416, v10
    v_add_u32 v151, 7392, v10
    v_add_u32 v152, 6368, v10
    v_add_u32 v153, 5344, v10
    v_lshl_add_u32 v10, v3, 1, v4
    v_lshlrev_b32 v10, 4, v10
    v_add_u32 v154, 480, v10
    v_lshlrev_b32 v160, 5, v3
    v_lshl_add_u32 v161, v4, 3, v160
    v_lshl_add_u32 v160, v5, 4, v160
    v_xor_b32 v6, 1, v6
    v_lshl_add_u32 v160, v6, 9, v160
L2v2b:
    v_mov_b32 v8, s73
L2lf:
    ds_read_b32 v9, v8 offset:0
    s_waitcnt lgkmcnt(0)
    v_readfirstlane_b32 s74, v9
    s_nop 0
    s_cmp_eq_u32 s74, 1
    s_cbranch_scc1 L2lfok
    s_add_u32 s96, s96, 1
    s_cmp_gt_u32 s96, 0x80000
    s_cbranch_scc1 L2lfok
    s_sleep 1
    s_branch L2lf
L2lfok:
    s_sub_u32 s44, s67, s75
    v_add_u32 v140, s44, v150
    v_add_u32 v141, s44, v151
    v_add_u32 v142, s44, v152
    v_add_u32 v143, s44, v153
    v_add_u32_e64 v144, s44, v154
    ds_read2_b32 v[8:9], v140 offset0:128 offset1:129
    ds_read2_b32 v[10:11], v140 offset0:130 offset1:131
    ds_read_b128 v[40:43], v144 offset:0
    ds_read2_b32 v[12:13], v140 offset0:0 offset1:1
    ds_read2_b32 v[14:15], v140 offset0:2 offset1:3
    ds_read_b128 v[44:47], v144 offset:512
    ds_read2_b32 v[16:17], v141 offset0:128 offset1:129
    ds_read2_b32 v[18:19], v141 offset0:130 offset1:131
    ds_read_b128 v[48:51], v144 offset:1024
    ds_read2_b32 v[20:21], v141 offset0:0 offset1:1
    ds_read2_b32 v[22:23], v141 offset0:2 offset1:3
    ds_read_b128 v[52:55], v144 offset:1536
    ds_read2_b32 v[24:25], v142 offset0:128 offset1:129
    ds_read2_b32 v[26:27], v142 offset0:130 offset1:131
    ds_read_b128 v[56:59], v144 offset:2048
    ds_read2_b32 v[28:29], v142 offset0:0 offset1:1
    ds_read2_b32 v[30:31], v142 offset0:2 offset1:3
    ds_read_b128 v[60:63], v144 offset:2560
    ds_read2_b32 v[32:33], v143 offset0:128 offset1:129
    ds_read2_b32 v[34:35], v143 offset0:130 offset1:131
    ds_read_b128 v[64:67], v144 offset:3072
    ds_read2_b32 v[36:37], v143 offset0:0 offset1:1
    ds_read2_b32 v[38:39], v143 offset0:2 offset1:3
    ds_read_b128 v[68:71], v144 offset:3584
    v_subrev_u32 v140, 64, v140
    v_subrev_u32 v141, 64, v141
    v_subrev_u32 v142, 64, v142
    v_subrev_u32 v143, 64, v143
    v_subrev_u32 v144, 64, v144
    v_mov_b32 v200, 0
    v_mov_b32 v201, 0
    v_mov_b32 v202, 0
    v_mov_b32 v203, 0
    v_mov_b32 v204, 0
    v_mov_b32 v205, 0
    v_mov_b32 v206, 0
    v_mov_b32 v207, 0
    v_mov_b32 v208, 0
    v_mov_b32 v209, 0
    v_mov_b32 v210, 0
    v_mov_b32 v211, 0
    v_mov_b32 v212, 0
    v_mov_b32 v213, 0
    v_mov_b32 v214, 0
    v_mov_b32 v215, 0
    v_mov_b32 v216, 0
    v_mov_b32 v217, 0
    v_mov_b32 v218, 0
    v_mov_b32 v219, 0
    v_mov_b32 v220, 0
    v_mov_b32 v221, 0
    v_mov_b32 v222, 0
    v_mov_b32 v223, 0
    v_mov_b32 v224, 0
    v_mov_b32 v225, 0
    v_mov_b32 v226, 0
    v_mov_b32 v227, 0
    v_mov_b32 v228, 0
    v_mov_b32 v229, 0
    v_mov_b32 v230, 0
    v_mov_b32_e64 v231, 0
    s_mov_b32 s45, 0
L2v2loop:
    s_waitcnt lgkmcnt(0)
    v_mfma_f32_16x16x32_bf16 v[200:203], v[8:11], v[68:71], v[200:203]
    ds_read2_b32 v[72:73], v140 offset0:128 offset1:129
    v_mfma_f32_16x16x32_bf16 v[200:203], v[12:15], v[64:67], v[200:203]
    ds_read2_b32 v[74:75], v140 offset0:130 offset1:131
    v_mfma_f32_16x16x32_bf16 v[200:203], v[16:19], v[60:63], v[200:203]
    ds_read_b128 v[104:107], v144 offset:0
    v_mfma_f32_16x16x32_bf16 v[200:203], v[20:23], v[56:59], v[200:203]
    ds_read2_b32 v[76:77], v140 offset0:0 offset1:1
    v_mfma_f32_16x16x32_bf16 v[200:203], v[24:27], v[52:55], v[200:203]
    ds_read2_b32 v[78:79], v140 offset0:2 offset1:3
    v_mfma_f32_16x16x32_bf16 v[200:203], v[28:31], v[48:51], v[200:203]
    ds_read_b128 v[108:111], v144 offset:512
    v_mfma_f32_16x16x32_bf16 v[200:203], v[32:35], v[44:47], v[200:203]
    ds_read2_b32 v[80:81], v141 offset0:128 offset1:129
    v_mfma_f32_16x16x32_bf16 v[200:203], v[36:39], v[40:43], v[200:203]
    ds_read2_b32 v[82:83], v141 offset0:130 offset1:131
    v_mfma_f32_16x16x32_bf16 v[204:207], v[8:11], v[64:67], v[204:207]
    ds_read_b128 v[112:115], v144 offset:1024
    v_mfma_f32_16x16x32_bf16 v[204:207], v[12:15], v[60:63], v[204:207]
    ds_read2_b32 v[84:85], v141 offset0:0 offset1:1
    v_mfma_f32_16x16x32_bf16 v[204:207], v[16:19], v[56:59], v[204:207]
    ds_read2_b32 v[86:87], v141 offset0:2 offset1:3
    v_mfma_f32_16x16x32_bf16 v[204:207], v[20:23], v[52:55], v[204:207]
    ds_read_b128 v[116:119], v144 offset:1536
    v_mfma_f32_16x16x32_bf16 v[204:207], v[24:27], v[48:51], v[204:207]
    ds_read2_b32 v[88:89], v142 offset0:128 offset1:129
    v_mfma_f32_16x16x32_bf16 v[204:207], v[28:31], v[44:47], v[204:207]
    ds_read2_b32 v[90:91], v142 offset0:130 offset1:131
    v_mfma_f32_16x16x32_bf16 v[204:207], v[32:35], v[40:43], v[204:207]
    ds_read_b128 v[120:123], v144 offset:2048
    v_mfma_f32_16x16x32_bf16 v[208:211], v[8:11], v[60:63], v[208:211]
    ds_read2_b32 v[92:93], v142 offset0:0 offset1:1
    v_mfma_f32_16x16x32_bf16 v[208:211], v[12:15], v[56:59], v[208:211]
    ds_read2_b32 v[94:95], v142 offset0:2 offset1:3
    v_mfma_f32_16x16x32_bf16 v[208:211], v[16:19], v[52:55], v[208:211]
    ds_read_b128 v[124:127], v144 offset:2560
    v_mfma_f32_16x16x32_bf16 v[208:211], v[20:23], v[48:51], v[208:211]
    ds_read2_b32 v[96:97], v143 offset0:128 offset1:129
    v_mfma_f32_16x16x32_bf16 v[208:211], v[24:27], v[44:47], v[208:211]
    ds_read2_b32 v[98:99], v143 offset0:130 offset1:131
    v_mfma_f32_16x16x32_bf16 v[208:211], v[28:31], v[40:43], v[208:211]
    ds_read_b128 v[128:131], v144 offset:3072
    v_mfma_f32_16x16x32_bf16 v[212:215], v[8:11], v[56:59], v[212:215]
    ds_read2_b32 v[100:101], v143 offset0:0 offset1:1
    v_mfma_f32_16x16x32_bf16 v[212:215], v[12:15], v[52:55], v[212:215]
    ds_read2_b32 v[102:103], v143 offset0:2 offset1:3
    v_mfma_f32_16x16x32_bf16 v[212:215], v[16:19], v[48:51], v[212:215]
    ds_read_b128 v[132:135], v144 offset:3584
    v_mfma_f32_16x16x32_bf16 v[212:215], v[20:23], v[44:47], v[212:215]
    v_subrev_u32 v140, 64, v140
    v_mfma_f32_16x16x32_bf16 v[212:215], v[24:27], v[40:43], v[212:215]
    v_subrev_u32 v141, 64, v141
    v_mfma_f32_16x16x32_bf16 v[216:219], v[8:11], v[52:55], v[216:219]
    v_subrev_u32 v142, 64, v142
    v_mfma_f32_16x16x32_bf16 v[216:219], v[12:15], v[48:51], v[216:219]
    v_subrev_u32 v143, 64, v143
    v_mfma_f32_16x16x32_bf16 v[216:219], v[16:19], v[44:47], v[216:219]
    v_subrev_u32 v144, 64, v144
    v_mfma_f32_16x16x32_bf16 v[216:219], v[20:23], v[40:43], v[216:219]
    s_add_u32 s45, s45, 1
    v_mfma_f32_16x16x32_bf16 v[220:223], v[8:11], v[48:51], v[220:223]
    s_cmp_lt_u32 s45, s77
    s_nop 0
    v_mfma_f32_16x16x32_bf16 v[220:223], v[12:15], v[44:47], v[220:223]
    v_mfma_f32_16x16x32_bf16 v[220:223], v[16:19], v[40:43], v[220:223]
    v_mfma_f32_16x16x32_bf16 v[224:227], v[8:11], v[44:47], v[224:227]
    v_mfma_f32_16x16x32_bf16 v[224:227], v[12:15], v[40:43], v[224:227]
    v_mfma_f32_16x16x32_bf16 v[228:231], v[8:11], v[40:43], v[228:231]
    s_cbranch_scc0 L2v2loopx
    s_waitcnt lgkmcnt(0)
    v_mfma_f32_16x16x32_bf16 v[200:203], v[72:75], v[132:135], v[200:203]
    ds_read2_b32 v[8:9], v140 offset0:128 offset1:129
    v_mfma_f32_16x16x32_bf16 v[200:203], v[76:79], v[128:131], v[200:203]
    ds_read2_b32 v[10:11], v140 offset0:130 offset1:131
    v_mfma_f32_16x16x32_bf16 v[200:203], v[80:83], v[124:127], v[200:203]
    ds_read_b128 v[40:43], v144 offset:0
    v_mfma_f32_16x16x32_bf16 v[200:203], v[84:87], v[120:123], v[200:203]
    ds_read2_b32 v[12:13], v140 offset0:0 offset1:1
    v_mfma_f32_16x16x32_bf16 v[200:203], v[88:91], v[116:119], v[200:203]
    ds_read2_b32 v[14:15], v140 offset0:2 offset1:3
    v_mfma_f32_16x16x32_bf16 v[200:203], v[92:95], v[112:115], v[200:203]
    ds_read_b128 v[44:47], v144 offset:512
    v_mfma_f32_16x16x32_bf16 v[200:203], v[96:99], v[108:111], v[200:203]
    ds_read2_b32 v[16:17], v141 offset0:128 offset1:129
    v_mfma_f32_16x16x32_bf16 v[200:203], v[100:103], v[104:107], v[200:203]
    ds_read2_b32 v[18:19], v141 offset0:130 offset1:131
    v_mfma_f32_16x16x32_bf16 v[204:207], v[72:75], v[128:131], v[204:207]
    ds_read_b128 v[48:51], v144 offset:1024
    v_mfma_f32_16x16x32_bf16 v[204:207], v[76:79], v[124:127], v[204:207]
    ds_read2_b32 v[20:21], v141 offset0:0 offset1:1
    v_mfma_f32_16x16x32_bf16 v[204:207], v[80:83], v[120:123], v[204:207]
    ds_read2_b32 v[22:23], v141 offset0:2 offset1:3
    v_mfma_f32_16x16x32_bf16 v[204:207], v[84:87], v[116:119], v[204:207]
    ds_read_b128 v[52:55], v144 offset:1536
    v_mfma_f32_16x16x32_bf16 v[204:207], v[88:91], v[112:115], v[204:207]
    ds_read2_b32 v[24:25], v142 offset0:128 offset1:129
    v_mfma_f32_16x16x32_bf16 v[204:207], v[92:95], v[108:111], v[204:207]
    ds_read2_b32 v[26:27], v142 offset0:130 offset1:131
    v_mfma_f32_16x16x32_bf16 v[204:207], v[96:99], v[104:107], v[204:207]
    ds_read_b128 v[56:59], v144 offset:2048
    v_mfma_f32_16x16x32_bf16 v[208:211], v[72:75], v[124:127], v[208:211]
    ds_read2_b32 v[28:29], v142 offset0:0 offset1:1
    v_mfma_f32_16x16x32_bf16 v[208:211], v[76:79], v[120:123], v[208:211]
    ds_read2_b32 v[30:31], v142 offset0:2 offset1:3
    v_mfma_f32_16x16x32_bf16 v[208:211], v[80:83], v[116:119], v[208:211]
    ds_read_b128 v[60:63], v144 offset:2560
    v_mfma_f32_16x16x32_bf16 v[208:211], v[84:87], v[112:115], v[208:211]
    ds_read2_b32 v[32:33], v143 offset0:128 offset1:129
    v_mfma_f32_16x16x32_bf16 v[208:211], v[88:91], v[108:111], v[208:211]
    ds_read2_b32 v[34:35], v143 offset0:130 offset1:131
    v_mfma_f32_16x16x32_bf16 v[208:211], v[92:95], v[104:107], v[208:211]
    ds_read_b128 v[64:67], v144 offset:3072
    v_mfma_f32_16x16x32_bf16 v[212:215], v[72:75], v[120:123], v[212:215]
    ds_read2_b32 v[36:37], v143 offset0:0 offset1:1
    v_mfma_f32_16x16x32_bf16 v[212:215], v[76:79], v[116:119], v[212:215]
    ds_read2_b32 v[38:39], v143 offset0:2 offset1:3
    v_mfma_f32_16x16x32_bf16 v[212:215], v[80:83], v[112:115], v[212:215]
    ds_read_b128 v[68:71], v144 offset:3584
    v_mfma_f32_16x16x32_bf16 v[212:215], v[84:87], v[108:111], v[212:215]
    v_subrev_u32 v140, 64, v140
    v_mfma_f32_16x16x32_bf16 v[212:215], v[88:91], v[104:107], v[212:215]
    v_subrev_u32 v141, 64, v141
    v_mfma_f32_16x16x32_bf16 v[216:219], v[72:75], v[116:119], v[216:219]
    v_subrev_u32 v142, 64, v142
    v_mfma_f32_16x16x32_bf16 v[216:219], v[76:79], v[112:115], v[216:219]
    v_subrev_u32 v143, 64, v143
    v_mfma_f32_16x16x32_bf16 v[216:219], v[80:83], v[108:111], v[216:219]
    v_subrev_u32 v144, 64, v144
    v_mfma_f32_16x16x32_bf16 v[216:219], v[84:87], v[104:107], v[216:219]
    s_add_u32 s45, s45, 1
    v_mfma_f32_16x16x32_bf16 v[220:223], v[72:75], v[112:115], v[220:223]
    s_cmp_lt_u32 s45, s77
    s_nop 0
    v_mfma_f32_16x16x32_bf16 v[220:223], v[76:79], v[108:111], v[220:223]
    v_mfma_f32_16x16x32_bf16 v[220:223], v[80:83], v[104:107], v[220:223]
    v_mfma_f32_16x16x32_bf16 v[224:227], v[72:75], v[108:111], v[224:227]
    v_mfma_f32_16x16x32_bf16 v[224:227], v[76:79], v[104:107], v[224:227]
    v_mfma_f32_16x16x32_bf16 v[228:231], v[72:75], v[104:107], v[228:231]
    s_cbranch_scc1 L2v2loop
L2v2loopx:
    s_nop 7
    s_waitcnt lgkmcnt(0)
    v_add_u32 v10, s48, v1
    ds_write_b128 v10, v[200:203] offset:0
    ds_write_b128 v10, v[204:207] offset:1024
    ds_write_b128 v10, v[208:211] offset:2048
    ds_write_b128 v10, v[212:215] offset:3072
    ds_write_b128 v10, v[216:219] offset:4096
    ds_write_b128 v10, v[220:223] offset:5120
    ds_write_b128 v10, v[224:227] offset:6144
    ds_write_b128 v10, v[228:231] offset:7168
    s_add_u32 s49, s73, 16
    s_waitcnt lgkmcnt(0)
    v_mov_b32 v8, s49
    v_mov_b32 v9, 1
    ds_write_b32 v8, v9 offset:0
    s_add_u32 s67, s67, 14720
    s_add_u32 s48, s48, 8192
    s_add_u32 s73, s73, 4
    s_sub_u32 s68, s68, 1
    s_cmp_lg_u32 s68, 0
    s_cbranch_scc1 L2v2b
    s_branch L2stage
L2cdone:
    s_branch L2cend
L2stage:
    s_cmp_lg_u32 s3, 3
    s_cbranch_scc1 L2cend
    s_setprio 3
    s_mov_b32 s73, 32
    v_mov_b32 v8, s73
L2trig:
    ds_read_b32 v9, v8 offset:0
    s_waitcnt lgkmcnt(0)
    v_readfirstlane_b32 s74, v9
    s_nop 0
    s_cmp_eq_u32 s74, 1
    s_cbranch_scc1 L2trigok
    s_add_u32 s96, s96, 1
    s_cmp_gt_u32 s96, 0x80000
    s_cbranch_scc1 L2trigok
    s_sleep 4
    s_branch L2trig
L2trigok:
    s_mul_i32 s66, s5, 327680
    s_lshl_b32 s65, s4, 7
    s_add_u32 s66, s66, s65
    s_add_u32 s66, s66, 20971520
    v_lshrrev_b32 v8, 3, v0
    v_lshlrev_b32 v8, 12, v8
    v_and_b32 v9, 7, v0
    v_lshl_add_u32 v8, v9, 4, v8
    v_add_u32 v9, 142720, v1
    s_mov_b32 s65, 0
L2poll:
    s_mov_b32 s64, s66
    s_nop 0
    buffer_load_dwordx4 v[16:19], v8, s[16:19], s64 offen sc1
    s_add_u32 s64, s64, 32768
    buffer_load_dwordx4 v[20:23], v8, s[16:19], s64 offen sc1
    s_add_u32 s64, s64, 32768
    buffer_load_dwordx4 v[24:27], v8, s[16:19], s64 offen sc1
    s_add_u32 s64, s64, 32768
    buffer_load_dwordx4 v[28:31], v8, s[16:19], s64 offen sc1
    s_add_u32 s64, s64, 32768
    buffer_load_dwordx4 v[32:35], v8, s[16:19], s64 offen sc1
    s_add_u32 s64, s64, 32768
    buffer_load_dwordx4 v[36:39], v8, s[16:19], s64 offen sc1
    s_add_u32 s64, s64, 32768
    buffer_load_dwordx4 v[40:43], v8, s[16:19], s64 offen sc1
    s_add_u32 s64, s64, 32768
    buffer_load_dwordx4 v[44:47], v8, s[16:19], s64 offen sc1
    s_add_u32 s64, s64, 32768
    buffer_load_dwordx4 v[48:51], v8, s[16:19], s64 offen sc1
    s_add_u32 s64, s64, 32768
    buffer_load_dwordx4 v[52:55], v8, s[16:19], s64 offen sc1
    s_waitcnt vmcnt(9)
    ds_write_b128 v9, v[16:19] offset:0
    v_max_u32 v10, v16, v16
    s_waitcnt vmcnt(8)
    ds_write_b128 v9, v[20:23] offset:1024
    v_max_u32 v10, v20, v10
    s_waitcnt vmcnt(7)
    ds_write_b128 v9, v[24:27] offset:2048
    v_max_u32 v10, v24, v10
    s_waitcnt vmcnt(6)
    ds_write_b128 v9, v[28:31] offset:3072
    v_max_u32 v10, v28, v10
    s_waitcnt vmcnt(5)
    ds_write_b128 v9, v[32:35] offset:4096
    v_max_u32 v10, v32, v10
    s_waitcnt vmcnt(4)
    ds_write_b128 v9, v[36:39] offset:5120
    v_max_u32 v10, v36, v10
    s_waitcnt vmcnt(3)
    ds_write_b128 v9, v[40:43] offset:6144
    v_max_u32 v10, v40, v10
    s_waitcnt vmcnt(2)
    ds_write_b128 v9, v[44:47] offset:7168
    v_max_u32 v10, v44, v10
    s_waitcnt vmcnt(1)
    ds_write_b128 v9, v[48:51] offset:8192
    v_max_u32 v10, v48, v10
    s_waitcnt vmcnt(0)
    ds_write_b128 v9, v[52:55] offset:9216
    v_max_u32 v10, v52, v10
    v_cmp_eq_u32 vcc, -1, v10
    s_nop 0
    s_cmp_eq_u64 vcc, 0
    s_cbranch_scc1 L2pollok
    s_add_u32 s65, s65, 1
    s_cmp_gt_u32 s65, 0x20000
    s_cbranch_scc1 L2pollok
    s_sleep 8
    s_branch L2poll
L2pollok:
    s_waitcnt lgkmcnt(0)
L2cend:
    s_endpgm
L2g2:
    s_setprio 0
    s_sub_u32 s3, s3, 4
    s_mul_i32 s64, s3, 480
    s_mul_i32 s65, s5, 5
    s_add_u32 s64, s64, s65
    s_lshl_b32 s64, s64, 10
    s_nop 0
    s_add_u32 s64, s64, 10485760
    v_add_u32 v2, 4096, v1
    s_mul_i32 s65, s3, 12288
    s_add_u32 s65, s65, 12582912
    s_add_u32 s66, s3, 0
    s_and_b32 s66, s66, 3
    s_lshl_b32 s67, s4, 2
    s_add_u32 s66, s66, s67
    s_mul_i32 s66, s66, 49152
    s_add_u32 s68, s66, s65
    s_add_u32 s66, s3, 1
    s_and_b32 s66, s66, 3
    s_lshl_b32 s67, s4, 2
    s_add_u32 s66, s66, s67
    s_mul_i32 s66, s66, 49152
    s_add_u32 s69, s66, s65
    s_add_u32 s66, s3, 2
    s_and_b32 s66, s66, 3
    s_lshl_b32 s67, s4, 2
    s_add_u32 s66, s66, s67
    s_mul_i32 s66, s66, 49152
    s_add_u32 s70, s66, s65
    s_add_u32 s66, s3, 3
    s_and_b32 s66, s66, 3
    s_lshl_b32 s67, s4, 2
    s_add_u32 s66, s66, s67
    s_mul_i32 s66, s66, 49152
    s_add_u32 s71, s66, s65
    s_waitcnt lgkmcnt(0)
    s_mov_b32 s16, s58
    s_mov_b32 s17, s59
    s_mov_b32 s18, 268435456
    s_mov_b32 s19, 0x20000
    s_barrier
    buffer_load_dwordx4 v[96:99], v1, s[16:19], s64 offen offset:0
    buffer_load_dwordx4 v[100:103], v1, s[16:19], s64 offen offset:1024
    buffer_load_dwordx4 v[104:107], v1, s[16:19], s64 offen offset:2048
    buffer_load_dwordx4 v[108:111], v1, s[16:19], s64 offen offset:3072
    buffer_load_dwordx4 v[112:115], v2, s[16:19], s64 offen offset:0
    buffer_load_dwordx4 v[116:119], v1, s[16:19], s68 offen offset:0
    buffer_load_dwordx4 v[120:123], v1, s[16:19], s69 offen offset:0
    buffer_load_dwordx4 v[124:127], v1, s[16:19], s70 offen offset:0
    buffer_load_dwordx4 v[128:131], v1, s[16:19], s71 offen offset:0
    s_add_u32 s64, s64, 40960
    buffer_load_dwordx4 v[132:135], v1, s[16:19], s64 offen offset:0
    buffer_load_dwordx4 v[136:139], v1, s[16:19], s64 offen offset:1024
    buffer_load_dwordx4 v[140:143], v1, s[16:19], s64 offen offset:2048
    buffer_load_dwordx4 v[144:147], v1, s[16:19], s64 offen offset:3072
    buffer_load_dwordx4 v[148:151], v2, s[16:19], s64 offen offset:0
    buffer_load_dwordx4 v[152:155], v1, s[16:19], s68 offen offset:1024
    buffer_load_dwordx4 v[156:159], v1, s[16:19], s69 offen offset:1024
    buffer_load_dwordx4 v[160:163], v1, s[16:19], s70 offen offset:1024
    buffer_load_dwordx4 v[164:167], v1, s[16:19], s71 offen offset:1024
    s_add_u32 s64, s64, 40960
    buffer_load_dwordx4 v[168:171], v1, s[16:19], s64 offen offset:0
    buffer_load_dwordx4 v[172:175], v1, s[16:19], s64 offen offset:1024
    buffer_load_dwordx4 v[176:179], v1, s[16:19], s64 offen offset:2048
    buffer_load_dwordx4 v[180:183], v1, s[16:19], s64 offen offset:3072
    buffer_load_dwordx4 v[184:187], v2, s[16:19], s64 offen offset:0
    buffer_load_dwordx4 v[188:191], v1, s[16:19], s68 offen offset:2048
    buffer_load_dwordx4 v[192:195], v1, s[16:19], s69 offen offset:2048
    buffer_load_dwordx4 v[196:199], v1, s[16:19], s70 offen offset:2048
    buffer_load_dwordx4 v[200:203], v1, s[16:19], s71 offen offset:2048
    s_add_u32 s64, s64, 40960
    buffer_load_dwordx4 v[204:207], v1, s[16:19], s64 offen offset:0
    buffer_load_dwordx4 v[208:211], v1, s[16:19], s64 offen offset:1024
    buffer_load_dwordx4 v[212:215], v1, s[16:19], s64 offen offset:2048
    buffer_load_dwordx4 v[216:219], v1, s[16:19], s64 offen offset:3072
    buffer_load_dwordx4 v[220:223], v2, s[16:19], s64 offen offset:0
    buffer_load_dwordx4 v[224:227], v1, s[16:19], s68 offen offset:3072
    buffer_load_dwordx4 v[228:231], v1, s[16:19], s69 offen offset:3072
    buffer_load_dwordx4 v[232:235], v1, s[16:19], s70 offen offset:3072
    buffer_load_dwordx4 v[236:239], v1, s[16:19], s71 offen offset:3072
    s_mov_b32 s8, s32
    s_mov_b32 s9, s33
    s_mov_b32 s10, 2621440
    s_mov_b32 s11, 0x20000
    s_mov_b32 s12, s34
    s_mov_b32 s13, s35
    s_mov_b32 s14, 2621440
    s_mov_b32 s15, 0x20000
    v_and_b32 v3, 15, v0
    v_lshrrev_b32 v4, 4, v0
    v_mul_u32_u24 v5, 1280, v3
    v_lshl_add_u32 v6, v4, 3, v5
    v_lshl_add_u32 v5, v4, 4, v5
    s_lshl_b32 s72, s4, 6
    s_lshl_b32 s73, s3, 4
    s_add_u32 s72, s72, s73
    s_mul_i32 s72, s72, 1280
    s_mul_i32 s73, s5, 160
    s_add_u32 s72, s72, s73
    s_mul_i32 s74, s3, 18432
    s_add_u32 s74, s74, 68992
    v_add_u32 v7, s74, v1
    v_bfe_u32 v8, v0, 2, 2
    v_and_b32 v9, 3, v0
    v_lshl_add_u32 v10, v4, 3, v8
    v_lshl_add_u32 v11, v4, 2, v8
    v_lshlrev_b32 v10, 7, v10
    v_lshlrev_b32 v11, 7, v11
    s_lshl_b32 s73, s3, 5
    s_add_u32 s73, s73, 142720
    v_lshl_add_u32 v9, v9, 3, s73
    v_add_u32 v10, v10, v9
    v_add_u32 v11, v11, v9
    s_sub_u32 s73, s3, 1
    s_and_b32 s73, s73, 3
    s_mul_i32 s73, s73, 18432
    s_add_u32 s73, s73, 68992
    v_add_u32 v12, s73, v1
    s_sub_u32 s73, s3, 2
    s_and_b32 s73, s73, 3
    s_mul_i32 s73, s73, 18432
    s_add_u32 s73, s73, 74112
    v_add_u32 v13, s73, v1
    s_sub_u32 s73, s3, 3
    s_and_b32 s73, s73, 3
    s_mul_i32 s73, s73, 18432
    s_add_u32 s73, s73, 79232
    v_add_u32 v14, s73, v1
    s_add_u32 s75, s64, 286720
    s_add_u32 m0, s74, 0
    s_nop 0
    buffer_load_dwordx4 v1, s[16:19], s75 offen offset:0 lds
    buffer_load_dwordx4 v1, s[16:19], s75 offen offset:1024 lds
    buffer_load_dwordx4 v1, s[16:19], s75 offen offset:2048 lds
    buffer_load_dwordx4 v1, s[16:19], s75 offen offset:3072 lds
    s_add_u32 m0, s74, 4096
    s_nop 0
    s_nop 0
    buffer_load_dwordx4 v2, s[16:19], s75 offen offset:0 lds
    s_add_u32 m0, s74, 5120
    s_add_u32 s76, s68, 10240
    buffer_load_dwordx4 v1, s[16:19], s76 offen lds
    s_add_u32 m0, s74, 6144
    s_add_u32 s76, s69, 10240
    buffer_load_dwordx4 v1, s[16:19], s76 offen lds
    s_add_u32 m0, s74, 7168
    s_add_u32 s76, s70, 10240
    buffer_load_dwordx4 v1, s[16:19], s76 offen lds
    s_add_u32 m0, s74, 8192
    s_add_u32 s76, s71, 10240
    buffer_load_dwordx4 v1, s[16:19], s76 offen lds
    s_add_u32 s75, s75, 40960
    s_add_u32 m0, s74, 9216
    s_nop 0
    s_nop 0
    buffer_load_dwordx4 v1, s[16:19], s75 offen offset:0 lds
    buffer_load_dwordx4 v1, s[16:19], s75 offen offset:1024 lds
    buffer_load_dwordx4 v1, s[16:19], s75 offen offset:2048 lds
    buffer_load_dwordx4 v1, s[16:19], s75 offen offset:3072 lds
    s_add_u32 m0, s74, 13312
    s_nop 0
    s_nop 0
    buffer_load_dwordx4 v2, s[16:19], s75 offen offset:0 lds
    s_add_u32 m0, s74, 14336
    s_add_u32 s76, s68, 11264
    buffer_load_dwordx4 v1, s[16:19], s76 offen lds
    s_add_u32 m0, s74, 15360
    s_add_u32 s76, s69, 11264
    buffer_load_dwordx4 v1, s[16:19], s76 offen lds
    s_add_u32 m0, s74, 16384
    s_add_u32 s76, s70, 11264
    buffer_load_dwordx4 v1, s[16:19], s76 offen lds
    s_add_u32 m0, s74, 17408
    s_add_u32 s76, s71, 11264
    buffer_load_dwordx4 v1, s[16:19], s76 offen lds
    s_add_u32 s75, s75, 40960
    s_waitcnt vmcnt(45)
    s_setprio 1
    v_mfma_f32_16x16x32_bf16 v[16:19], v[96:99], v[116:119], 0
    v_mfma_f32_16x16x32_bf16 v[20:23], v[96:99], v[120:123], 0
    v_mfma_f32_16x16x32_bf16 v[24:27], v[96:99], v[124:127], 0
    v_mfma_f32_16x16x32_bf16 v[28:31], v[96:99], v[128:131], 0
    s_add_u32 s64, s64, 40960
    buffer_load_dwordx4 v[96:99], v1, s[16:19], s64 offen offset:0
    v_mfma_f32_16x16x32_bf16 v[32:35], v[100:103], v[116:119], 0
    v_mfma_f32_16x16x32_bf16 v[36:39], v[100:103], v[120:123], 0
    v_mfma_f32_16x16x32_bf16 v[40:43], v[100:103], v[124:127], 0
    v_mfma_f32_16x16x32_bf16 v[44:47], v[100:103], v[128:131], 0
    buffer_load_dwordx4 v[100:103], v1, s[16:19], s64 offen offset:1024
    v_mfma_f32_16x16x32_bf16 v[48:51], v[104:107], v[116:119], 0
    v_mfma_f32_16x16x32_bf16 v[52:55], v[104:107], v[120:123], 0
    v_mfma_f32_16x16x32_bf16 v[56:59], v[104:107], v[124:127], 0
    v_mfma_f32_16x16x32_bf16 v[60:63], v[104:107], v[128:131], 0
    buffer_load_dwordx4 v[104:107], v1, s[16:19], s64 offen offset:2048
    v_mfma_f32_16x16x32_bf16 v[64:67], v[108:111], v[116:119], 0
    v_mfma_f32_16x16x32_bf16 v[68:71], v[108:111], v[120:123], 0
    v_mfma_f32_16x16x32_bf16 v[72:75], v[108:111], v[124:127], 0
    v_mfma_f32_16x16x32_bf16 v[76:79], v[108:111], v[128:131], 0
    buffer_load_dwordx4 v[108:111], v1, s[16:19], s64 offen offset:3072
    v_mfma_f32_16x16x32_bf16 v[80:83], v[112:115], v[116:119], 0
    v_mfma_f32_16x16x32_bf16 v[84:87], v[112:115], v[120:123], 0
    v_mfma_f32_16x16x32_bf16 v[88:91], v[112:115], v[124:127], 0
    v_mfma_f32_16x16x32_bf16 v[92:95], v[112:115], v[128:131], 0
    buffer_load_dwordx4 v[112:115], v2, s[16:19], s64 offen offset:0
    s_add_u32 s68, s68, 4096
    buffer_load_dwordx4 v[116:119], v1, s[16:19], s68 offen offset:0
    s_add_u32 s69, s69, 4096
    buffer_load_dwordx4 v[120:123], v1, s[16:19], s69 offen offset:0
    s_add_u32 s70, s70, 4096
    buffer_load_dwordx4 v[124:127], v1, s[16:19], s70 offen offset:0
    s_add_u32 s71, s71, 4096
    buffer_load_dwordx4 v[128:131], v1, s[16:19], s71 offen offset:0
    s_waitcnt vmcnt(45)
    s_nop 0
    v_mfma_f32_16x16x32_bf16 v[16:19], v[132:135], v[152:155], v[16:19]
    v_mfma_f32_16x16x32_bf16 v[20:23], v[132:135], v[156:159], v[20:23]
    v_mfma_f32_16x16x32_bf16 v[24:27], v[132:135], v[160:163], v[24:27]
    v_mfma_f32_16x16x32_bf16 v[28:31], v[132:135], v[164:167], v[28:31]
    s_add_u32 s64, s64, 40960
    buffer_load_dwordx4 v[132:135], v1, s[16:19], s64 offen offset:0
    v_mfma_f32_16x16x32_bf16 v[32:35], v[136:139], v[152:155], v[32:35]
    v_mfma_f32_16x16x32_bf16 v[36:39], v[136:139], v[156:159], v[36:39]
    v_mfma_f32_16x16x32_bf16 v[40:43], v[136:139], v[160:163], v[40:43]
    v_mfma_f32_16x16x32_bf16 v[44:47], v[136:139], v[164:167], v[44:47]
    buffer_load_dwordx4 v[136:139], v1, s[16:19], s64 offen offset:1024
    v_mfma_f32_16x16x32_bf16 v[48:51], v[140:143], v[152:155], v[48:51]
    v_mfma_f32_16x16x32_bf16 v[52:55], v[140:143], v[156:159], v[52:55]
    v_mfma_f32_16x16x32_bf16 v[56:59], v[140:143], v[160:163], v[56:59]
    v_mfma_f32_16x16x32_bf16 v[60:63], v[140:143], v[164:167], v[60:63]
    buffer_load_dwordx4 v[140:143], v1, s[16:19], s64 offen offset:2048
    v_mfma_f32_16x16x32_bf16 v[64:67], v[144:147], v[152:155], v[64:67]
    v_mfma_f32_16x16x32_bf16 v[68:71], v[144:147], v[156:159], v[68:71]
    v_mfma_f32_16x16x32_bf16 v[72:75], v[144:147], v[160:163], v[72:75]
    v_mfma_f32_16x16x32_bf16 v[76:79], v[144:147], v[164:167], v[76:79]
    buffer_load_dwordx4 v[144:147], v1, s[16:19], s64 offen offset:3072
    v_mfma_f32_16x16x32_bf16 v[80:83], v[148:151], v[152:155], v[80:83]
    v_mfma_f32_16x16x32_bf16 v[84:87], v[148:151], v[156:159], v[84:87]
    v_mfma_f32_16x16x32_bf16 v[88:91], v[148:151], v[160:163], v[88:91]
    v_mfma_f32_16x16x32_bf16 v[92:95], v[148:151], v[164:167], v[92:95]
    buffer_load_dwordx4 v[148:151], v2, s[16:19], s64 offen offset:0
    buffer_load_dwordx4 v[152:155], v1, s[16:19], s68 offen offset:1024
    buffer_load_dwordx4 v[156:159], v1, s[16:19], s69 offen offset:1024
    buffer_load_dwordx4 v[160:163], v1, s[16:19], s70 offen offset:1024
    buffer_load_dwordx4 v[164:167], v1, s[16:19], s71 offen offset:1024
    s_waitcnt vmcnt(45)
    s_nop 0
    v_mfma_f32_16x16x32_bf16 v[16:19], v[168:171], v[188:191], v[16:19]
    v_mfma_f32_16x16x32_bf16 v[20:23], v[168:171], v[192:195], v[20:23]
    v_mfma_f32_16x16x32_bf16 v[24:27], v[168:171], v[196:199], v[24:27]
    v_mfma_f32_16x16x32_bf16 v[28:31], v[168:171], v[200:203], v[28:31]
    s_add_u32 s64, s64, 40960
    buffer_load_dwordx4 v[168:171], v1, s[16:19], s64 offen offset:0
    v_mfma_f32_16x16x32_bf16 v[32:35], v[172:175], v[188:191], v[32:35]
    v_mfma_f32_16x16x32_bf16 v[36:39], v[172:175], v[192:195], v[36:39]
    v_mfma_f32_16x16x32_bf16 v[40:43], v[172:175], v[196:199], v[40:43]
    v_mfma_f32_16x16x32_bf16 v[44:47], v[172:175], v[200:203], v[44:47]
    buffer_load_dwordx4 v[172:175], v1, s[16:19], s64 offen offset:1024
    v_mfma_f32_16x16x32_bf16 v[48:51], v[176:179], v[188:191], v[48:51]
    v_mfma_f32_16x16x32_bf16 v[52:55], v[176:179], v[192:195], v[52:55]
    v_mfma_f32_16x16x32_bf16 v[56:59], v[176:179], v[196:199], v[56:59]
    v_mfma_f32_16x16x32_bf16 v[60:63], v[176:179], v[200:203], v[60:63]
    buffer_load_dwordx4 v[176:179], v1, s[16:19], s64 offen offset:2048
    v_mfma_f32_16x16x32_bf16 v[64:67], v[180:183], v[188:191], v[64:67]
    v_mfma_f32_16x16x32_bf16 v[68:71], v[180:183], v[192:195], v[68:71]
    v_mfma_f32_16x16x32_bf16 v[72:75], v[180:183], v[196:199], v[72:75]
    v_mfma_f32_16x16x32_bf16 v[76:79], v[180:183], v[200:203], v[76:79]
    buffer_load_dwordx4 v[180:183], v1, s[16:19], s64 offen offset:3072
    v_mfma_f32_16x16x32_bf16 v[80:83], v[184:187], v[188:191], v[80:83]
    v_mfma_f32_16x16x32_bf16 v[84:87], v[184:187], v[192:195], v[84:87]
    v_mfma_f32_16x16x32_bf16 v[88:91], v[184:187], v[196:199], v[88:91]
    v_mfma_f32_16x16x32_bf16 v[92:95], v[184:187], v[200:203], v[92:95]
    buffer_load_dwordx4 v[184:187], v2, s[16:19], s64 offen offset:0
    buffer_load_dwordx4 v[188:191], v1, s[16:19], s68 offen offset:2048
    buffer_load_dwordx4 v[192:195], v1, s[16:19], s69 offen offset:2048
    buffer_load_dwordx4 v[196:199], v1, s[16:19], s70 offen offset:2048
    buffer_load_dwordx4 v[200:203], v1, s[16:19], s71 offen offset:2048
    s_waitcnt vmcnt(45)
    s_nop 0
    v_mfma_f32_16x16x32_bf16 v[16:19], v[204:207], v[224:227], v[16:19]
    v_mfma_f32_16x16x32_bf16 v[20:23], v[204:207], v[228:231], v[20:23]
    v_mfma_f32_16x16x32_bf16 v[24:27], v[204:207], v[232:235], v[24:27]
    v_mfma_f32_16x16x32_bf16 v[28:31], v[204:207], v[236:239], v[28:31]
    s_add_u32 s64, s64, 40960
    buffer_load_dwordx4 v[204:207], v1, s[16:19], s64 offen offset:0
    v_mfma_f32_16x16x32_bf16 v[32:35], v[208:211], v[224:227], v[32:35]
    v_mfma_f32_16x16x32_bf16 v[36:39], v[208:211], v[228:231], v[36:39]
    v_mfma_f32_16x16x32_bf16 v[40:43], v[208:211], v[232:235], v[40:43]
    v_mfma_f32_16x16x32_bf16 v[44:47], v[208:211], v[236:239], v[44:47]
    buffer_load_dwordx4 v[208:211], v1, s[16:19], s64 offen offset:1024
    v_mfma_f32_16x16x32_bf16 v[48:51], v[212:215], v[224:227], v[48:51]
    v_mfma_f32_16x16x32_bf16 v[52:55], v[212:215], v[228:231], v[52:55]
    v_mfma_f32_16x16x32_bf16 v[56:59], v[212:215], v[232:235], v[56:59]
    v_mfma_f32_16x16x32_bf16 v[60:63], v[212:215], v[236:239], v[60:63]
    buffer_load_dwordx4 v[212:215], v1, s[16:19], s64 offen offset:2048
    v_mfma_f32_16x16x32_bf16 v[64:67], v[216:219], v[224:227], v[64:67]
    v_mfma_f32_16x16x32_bf16 v[68:71], v[216:219], v[228:231], v[68:71]
    v_mfma_f32_16x16x32_bf16 v[72:75], v[216:219], v[232:235], v[72:75]
    v_mfma_f32_16x16x32_bf16 v[76:79], v[216:219], v[236:239], v[76:79]
    buffer_load_dwordx4 v[216:219], v1, s[16:19], s64 offen offset:3072
    v_mfma_f32_16x16x32_bf16 v[80:83], v[220:223], v[224:227], v[80:83]
    v_mfma_f32_16x16x32_bf16 v[84:87], v[220:223], v[228:231], v[84:87]
    v_mfma_f32_16x16x32_bf16 v[88:91], v[220:223], v[232:235], v[88:91]
    v_mfma_f32_16x16x32_bf16 v[92:95], v[220:223], v[236:239], v[92:95]
    buffer_load_dwordx4 v[220:223], v2, s[16:19], s64 offen offset:0
    buffer_load_dwordx4 v[224:227], v1, s[16:19], s68 offen offset:3072
    buffer_load_dwordx4 v[228:231], v1, s[16:19], s69 offen offset:3072
    buffer_load_dwordx4 v[232:235], v1, s[16:19], s70 offen offset:3072
    buffer_load_dwordx4 v[236:239], v1, s[16:19], s71 offen offset:3072
    s_waitcnt vmcnt(27)
    s_nop 0
    v_mfma_f32_16x16x32_bf16 v[16:19], v[96:99], v[116:119], v[16:19]
    v_mfma_f32_16x16x32_bf16 v[20:23], v[96:99], v[120:123], v[20:23]
    v_mfma_f32_16x16x32_bf16 v[24:27], v[96:99], v[124:127], v[24:27]
    v_mfma_f32_16x16x32_bf16 v[28:31], v[96:99], v[128:131], v[28:31]
    s_add_u32 s64, s64, 40960
    buffer_load_dwordx4 v[96:99], v1, s[16:19], s64 offen offset:0
    v_mfma_f32_16x16x32_bf16 v[32:35], v[100:103], v[116:119], v[32:35]
    v_mfma_f32_16x16x32_bf16 v[36:39], v[100:103], v[120:123], v[36:39]
    v_mfma_f32_16x16x32_bf16 v[40:43], v[100:103], v[124:127], v[40:43]
    v_mfma_f32_16x16x32_bf16 v[44:47], v[100:103], v[128:131], v[44:47]
    buffer_load_dwordx4 v[100:103], v1, s[16:19], s64 offen offset:1024
    v_mfma_f32_16x16x32_bf16 v[48:51], v[104:107], v[116:119], v[48:51]
    v_mfma_f32_16x16x32_bf16 v[52:55], v[104:107], v[120:123], v[52:55]
    v_mfma_f32_16x16x32_bf16 v[56:59], v[104:107], v[124:127], v[56:59]
    v_mfma_f32_16x16x32_bf16 v[60:63], v[104:107], v[128:131], v[60:63]
    buffer_load_dwordx4 v[104:107], v1, s[16:19], s64 offen offset:2048
    v_mfma_f32_16x16x32_bf16 v[64:67], v[108:111], v[116:119], v[64:67]
    v_mfma_f32_16x16x32_bf16 v[68:71], v[108:111], v[120:123], v[68:71]
    v_mfma_f32_16x16x32_bf16 v[72:75], v[108:111], v[124:127], v[72:75]
    v_mfma_f32_16x16x32_bf16 v[76:79], v[108:111], v[128:131], v[76:79]
    buffer_load_dwordx4 v[108:111], v1, s[16:19], s64 offen offset:3072
    v_mfma_f32_16x16x32_bf16 v[80:83], v[112:115], v[116:119], v[80:83]
    v_mfma_f32_16x16x32_bf16 v[84:87], v[112:115], v[120:123], v[84:87]
    v_mfma_f32_16x16x32_bf16 v[88:91], v[112:115], v[124:127], v[88:91]
    v_mfma_f32_16x16x32_bf16 v[92:95], v[112:115], v[128:131], v[92:95]
    buffer_load_dwordx4 v[112:115], v2, s[16:19], s64 offen offset:0
    s_add_u32 s68, s68, 4096
    buffer_load_dwordx4 v[116:119], v1, s[16:19], s68 offen offset:0
    s_add_u32 s69, s69, 4096
    buffer_load_dwordx4 v[120:123], v1, s[16:19], s69 offen offset:0
    s_add_u32 s70, s70, 4096
    buffer_load_dwordx4 v[124:127], v1, s[16:19], s70 offen offset:0
    s_add_u32 s71, s71, 4096
    buffer_load_dwordx4 v[128:131], v1, s[16:19], s71 offen offset:0
    s_waitcnt vmcnt(27)
    s_nop 0
    v_mfma_f32_16x16x32_bf16 v[16:19], v[132:135], v[152:155], v[16:19]
    v_mfma_f32_16x16x32_bf16 v[20:23], v[132:135], v[156:159], v[20:23]
    v_mfma_f32_16x16x32_bf16 v[24:27], v[132:135], v[160:163], v[24:27]
    v_mfma_f32_16x16x32_bf16 v[28:31], v[132:135], v[164:167], v[28:31]
    s_add_u32 s64, s64, 40960
    buffer_load_dwordx4 v[132:135], v1, s[16:19], s64 offen offset:0
    v_mfma_f32_16x16x32_bf16 v[32:35], v[136:139], v[152:155], v[32:35]
    v_mfma_f32_16x16x32_bf16 v[36:39], v[136:139], v[156:159], v[36:39]
    v_mfma_f32_16x16x32_bf16 v[40:43], v[136:139], v[160:163], v[40:43]
    v_mfma_f32_16x16x32_bf16 v[44:47], v[136:139], v[164:167], v[44:47]
    buffer_load_dwordx4 v[136:139], v1, s[16:19], s64 offen offset:1024
    v_mfma_f32_16x16x32_bf16 v[48:51], v[140:143], v[152:155], v[48:51]
    v_mfma_f32_16x16x32_bf16 v[52:55], v[140:143], v[156:159], v[52:55]
    v_mfma_f32_16x16x32_bf16 v[56:59], v[140:143], v[160:163], v[56:59]
    v_mfma_f32_16x16x32_bf16 v[60:63], v[140:143], v[164:167], v[60:63]
    buffer_load_dwordx4 v[140:143], v1, s[16:19], s64 offen offset:2048
    v_mfma_f32_16x16x32_bf16 v[64:67], v[144:147], v[152:155], v[64:67]
    v_mfma_f32_16x16x32_bf16 v[68:71], v[144:147], v[156:159], v[68:71]
    v_mfma_f32_16x16x32_bf16 v[72:75], v[144:147], v[160:163], v[72:75]
    v_mfma_f32_16x16x32_bf16 v[76:79], v[144:147], v[164:167], v[76:79]
    buffer_load_dwordx4 v[144:147], v1, s[16:19], s64 offen offset:3072
    v_mfma_f32_16x16x32_bf16 v[80:83], v[148:151], v[152:155], v[80:83]
    v_mfma_f32_16x16x32_bf16 v[84:87], v[148:151], v[156:159], v[84:87]
    v_mfma_f32_16x16x32_bf16 v[88:91], v[148:151], v[160:163], v[88:91]
    v_mfma_f32_16x16x32_bf16 v[92:95], v[148:151], v[164:167], v[92:95]
    buffer_load_dwordx4 v[148:151], v2, s[16:19], s64 offen offset:0
    buffer_load_dwordx4 v[152:155], v1, s[16:19], s68 offen offset:1024
    buffer_load_dwordx4 v[156:159], v1, s[16:19], s69 offen offset:1024
    buffer_load_dwordx4 v[160:163], v1, s[16:19], s70 offen offset:1024
    buffer_load_dwordx4 v[164:167], v1, s[16:19], s71 offen offset:1024
    s_waitcnt vmcnt(27)
    s_setprio 0
    v_mfma_f32_16x16x32_bf16 v[16:19], v[168:171], v[188:191], v[16:19]
    v_mfma_f32_16x16x32_bf16 v[20:23], v[168:171], v[192:195], v[20:23]
    v_mfma_f32_16x16x32_bf16 v[24:27], v[168:171], v[196:199], v[24:27]
    v_mfma_f32_16x16x32_bf16 v[28:31], v[168:171], v[200:203], v[28:31]
    v_mfma_f32_16x16x32_bf16 v[32:35], v[172:175], v[188:191], v[32:35]
    v_mfma_f32_16x16x32_bf16 v[36:39], v[172:175], v[192:195], v[36:39]
    v_mfma_f32_16x16x32_bf16 v[40:43], v[172:175], v[196:199], v[40:43]
    v_mfma_f32_16x16x32_bf16 v[44:47], v[172:175], v[200:203], v[44:47]
    v_mfma_f32_16x16x32_bf16 v[48:51], v[176:179], v[188:191], v[48:51]
    v_mfma_f32_16x16x32_bf16 v[52:55], v[176:179], v[192:195], v[52:55]
    v_mfma_f32_16x16x32_bf16 v[56:59], v[176:179], v[196:199], v[56:59]
    v_mfma_f32_16x16x32_bf16 v[60:63], v[176:179], v[200:203], v[60:63]
    v_mfma_f32_16x16x32_bf16 v[64:67], v[180:183], v[188:191], v[64:67]
    v_mfma_f32_16x16x32_bf16 v[68:71], v[180:183], v[192:195], v[68:71]
    v_mfma_f32_16x16x32_bf16 v[72:75], v[180:183], v[196:199], v[72:75]
    v_mfma_f32_16x16x32_bf16 v[76:79], v[180:183], v[200:203], v[76:79]
    v_mfma_f32_16x16x32_bf16 v[80:83], v[184:187], v[188:191], v[80:83]
    v_mfma_f32_16x16x32_bf16 v[84:87], v[184:187], v[192:195], v[84:87]
    v_mfma_f32_16x16x32_bf16 v[88:91], v[184:187], v[196:199], v[88:91]
    v_mfma_f32_16x16x32_bf16 v[92:95], v[184:187], v[200:203], v[92:95]
    ds_read_b128 v[168:171], v7 offset:0
    ds_read_b128 v[172:175], v7 offset:1024
    ds_read_b128 v[176:179], v7 offset:2048
    ds_read_b128 v[180:183], v7 offset:3072
    ds_read_b128 v[184:187], v7 offset:4096
    ds_read_b128 v[188:191], v7 offset:5120
    ds_read_b128 v[192:195], v7 offset:6144
    ds_read_b128 v[196:199], v7 offset:7168
    ds_read_b128 v[200:203], v7 offset:8192
    buffer_load_dwordx4 v[240:243], v5, s[8:11], s72 offen
    buffer_load_dwordx4 v[244:247], v5, s[8:11], s72 offen offset:64
    buffer_load_dwordx2 v[248:249], v6, s[8:11], s72 offen offset:128
    s_waitcnt vmcnt(21)
    s_nop 0
    v_mfma_f32_16x16x32_bf16 v[16:19], v[204:207], v[224:227], v[16:19]
    v_mfma_f32_16x16x32_bf16 v[20:23], v[204:207], v[228:231], v[20:23]
    v_mfma_f32_16x16x32_bf16 v[24:27], v[204:207], v[232:235], v[24:27]
    v_mfma_f32_16x16x32_bf16 v[28:31], v[204:207], v[236:239], v[28:31]
    v_mfma_f32_16x16x32_bf16 v[32:35], v[208:211], v[224:227], v[32:35]
    v_mfma_f32_16x16x32_bf16 v[36:39], v[208:211], v[228:231], v[36:39]
    v_mfma_f32_16x16x32_bf16 v[40:43], v[208:211], v[232:235], v[40:43]
    v_mfma_f32_16x16x32_bf16 v[44:47], v[208:211], v[236:239], v[44:47]
    v_mfma_f32_16x16x32_bf16 v[48:51], v[212:215], v[224:227], v[48:51]
    v_mfma_f32_16x16x32_bf16 v[52:55], v[212:215], v[228:231], v[52:55]
    v_mfma_f32_16x16x32_bf16 v[56:59], v[212:215], v[232:235], v[56:59]
    v_mfma_f32_16x16x32_bf16 v[60:63], v[212:215], v[236:239], v[60:63]
    v_mfma_f32_16x16x32_bf16 v[64:67], v[216:219], v[224:227], v[64:67]
    v_mfma_f32_16x16x32_bf16 v[68:71], v[216:219], v[228:231], v[68:71]
    v_mfma_f32_16x16x32_bf16 v[72:75], v[216:219], v[232:235], v[72:75]
    v_mfma_f32_16x16x32_bf16 v[76:79], v[216:219], v[236:239], v[76:79]
    v_mfma_f32_16x16x32_bf16 v[80:83], v[220:223], v[224:227], v[80:83]
    v_mfma_f32_16x16x32_bf16 v[84:87], v[220:223], v[228:231], v[84:87]
    v_mfma_f32_16x16x32_bf16 v[88:91], v[220:223], v[232:235], v[88:91]
    v_mfma_f32_16x16x32_bf16 v[92:95], v[220:223], v[236:239], v[92:95]
    v_mov_b32 v15, 32
    v_mov_b32 v8, 1
    ds_write_b32 v15, v8 offset:0
    ds_read_b128 v[204:207], v7 offset:9216
    ds_read_b128 v[208:211], v7 offset:10240
    ds_read_b128 v[212:215], v7 offset:11264
    ds_read_b128 v[216:219], v7 offset:12288
    ds_read_b128 v[220:223], v7 offset:13312
    ds_read_b128 v[224:227], v7 offset:14336
    ds_read_b128 v[228:231], v7 offset:15360
    ds_read_b128 v[232:235], v7 offset:16384
    ds_read_b128 v[236:239], v7 offset:17408
    s_waitcnt vmcnt(12)
    s_nop 0
    v_mfma_f32_16x16x32_bf16 v[16:19], v[96:99], v[116:119], v[16:19]
    v_mfma_f32_16x16x32_bf16 v[20:23], v[96:99], v[120:123], v[20:23]
    v_mfma_f32_16x16x32_bf16 v[24:27], v[96:99], v[124:127], v[24:27]
    v_mfma_f32_16x16x32_bf16 v[28:31], v[96:99], v[128:131], v[28:31]
    v_mfma_f32_16x16x32_bf16 v[32:35], v[100:103], v[116:119], v[32:35]
    v_mfma_f32_16x16x32_bf16 v[36:39], v[100:103], v[120:123], v[36:39]
    v_mfma_f32_16x16x32_bf16 v[40:43], v[100:103], v[124:127], v[40:43]
    v_mfma_f32_16x16x32_bf16 v[44:47], v[100:103], v[128:131], v[44:47]
    v_mfma_f32_16x16x32_bf16 v[48:51], v[104:107], v[116:119], v[48:51]
    v_mfma_f32_16x16x32_bf16 v[52:55], v[104:107], v[120:123], v[52:55]
    v_mfma_f32_16x16x32_bf16 v[56:59], v[104:107], v[124:127], v[56:59]
    v_mfma_f32_16x16x32_bf16 v[60:63], v[104:107], v[128:131], v[60:63]
    v_mfma_f32_16x16x32_bf16 v[64:67], v[108:111], v[116:119], v[64:67]
    v_mfma_f32_16x16x32_bf16 v[68:71], v[108:111], v[120:123], v[68:71]
    v_mfma_f32_16x16x32_bf16 v[72:75], v[108:111], v[124:127], v[72:75]
    v_mfma_f32_16x16x32_bf16 v[76:79], v[108:111], v[128:131], v[76:79]
    v_mfma_f32_16x16x32_bf16 v[80:83], v[112:115], v[116:119], v[80:83]
    v_mfma_f32_16x16x32_bf16 v[84:87], v[112:115], v[120:123], v[84:87]
    v_mfma_f32_16x16x32_bf16 v[88:91], v[112:115], v[124:127], v[88:91]
    v_mfma_f32_16x16x32_bf16 v[92:95], v[112:115], v[128:131], v[92:95]
    s_waitcnt vmcnt(3)
    s_nop 0
    v_mfma_f32_16x16x32_bf16 v[16:19], v[132:135], v[152:155], v[16:19]
    v_mfma_f32_16x16x32_bf16 v[20:23], v[132:135], v[156:159], v[20:23]
    v_mfma_f32_16x16x32_bf16 v[24:27], v[132:135], v[160:163], v[24:27]
    v_mfma_f32_16x16x32_bf16 v[28:31], v[132:135], v[164:167], v[28:31]
    v_mfma_f32_16x16x32_bf16 v[32:35], v[136:139], v[152:155], v[32:35]
    v_mfma_f32_16x16x32_bf16 v[36:39], v[136:139], v[156:159], v[36:39]
    v_mfma_f32_16x16x32_bf16 v[40:43], v[136:139], v[160:163], v[40:43]
    v_mfma_f32_16x16x32_bf16 v[44:47], v[136:139], v[164:167], v[44:47]
    v_mfma_f32_16x16x32_bf16 v[48:51], v[140:143], v[152:155], v[48:51]
    v_mfma_f32_16x16x32_bf16 v[52:55], v[140:143], v[156:159], v[52:55]
    v_mfma_f32_16x16x32_bf16 v[56:59], v[140:143], v[160:163], v[56:59]
    v_mfma_f32_16x16x32_bf16 v[60:63], v[140:143], v[164:167], v[60:63]
    v_mfma_f32_16x16x32_bf16 v[64:67], v[144:147], v[152:155], v[64:67]
    v_mfma_f32_16x16x32_bf16 v[68:71], v[144:147], v[156:159], v[68:71]
    v_mfma_f32_16x16x32_bf16 v[72:75], v[144:147], v[160:163], v[72:75]
    v_mfma_f32_16x16x32_bf16 v[76:79], v[144:147], v[164:167], v[76:79]
    v_mfma_f32_16x16x32_bf16 v[80:83], v[148:151], v[152:155], v[80:83]
    v_mfma_f32_16x16x32_bf16 v[84:87], v[148:151], v[156:159], v[84:87]
    v_mfma_f32_16x16x32_bf16 v[88:91], v[148:151], v[160:163], v[88:91]
    v_mfma_f32_16x16x32_bf16 v[92:95], v[148:151], v[164:167], v[92:95]
    s_waitcnt lgkmcnt(9)
    s_nop 0
    v_mfma_f32_16x16x32_bf16 v[16:19], v[168:171], v[188:191], v[16:19]
    v_mfma_f32_16x16x32_bf16 v[20:23], v[168:171], v[192:195], v[20:23]
    v_mfma_f32_16x16x32_bf16 v[24:27], v[168:171], v[196:199], v[24:27]
    v_mfma_f32_16x16x32_bf16 v[28:31], v[168:171], v[200:203], v[28:31]
    v_mfma_f32_16x16x32_bf16 v[32:35], v[172:175], v[188:191], v[32:35]
    v_mfma_f32_16x16x32_bf16 v[36:39], v[172:175], v[192:195], v[36:39]
    v_mfma_f32_16x16x32_bf16 v[40:43], v[172:175], v[196:199], v[40:43]
    v_mfma_f32_16x16x32_bf16 v[44:47], v[172:175], v[200:203], v[44:47]
    v_mfma_f32_16x16x32_bf16 v[48:51], v[176:179], v[188:191], v[48:51]
    v_mfma_f32_16x16x32_bf16 v[52:55], v[176:179], v[192:195], v[52:55]
    v_mfma_f32_16x16x32_bf16 v[56:59], v[176:179], v[196:199], v[56:59]
    v_mfma_f32_16x16x32_bf16 v[60:63], v[176:179], v[200:203], v[60:63]
    v_mfma_f32_16x16x32_bf16 v[64:67], v[180:183], v[188:191], v[64:67]
    v_mfma_f32_16x16x32_bf16 v[68:71], v[180:183], v[192:195], v[68:71]
    v_mfma_f32_16x16x32_bf16 v[72:75], v[180:183], v[196:199], v[72:75]
    v_mfma_f32_16x16x32_bf16 v[76:79], v[180:183], v[200:203], v[76:79]
    v_mfma_f32_16x16x32_bf16 v[80:83], v[184:187], v[188:191], v[80:83]
    v_mfma_f32_16x16x32_bf16 v[84:87], v[184:187], v[192:195], v[84:87]
    v_mfma_f32_16x16x32_bf16 v[88:91], v[184:187], v[196:199], v[88:91]
    v_mfma_f32_16x16x32_bf16 v[92:95], v[184:187], v[200:203], v[92:95]
    s_waitcnt lgkmcnt(0)
    s_nop 0
    v_mfma_f32_16x16x32_bf16 v[16:19], v[204:207], v[224:227], v[16:19]
    v_mfma_f32_16x16x32_bf16 v[20:23], v[204:207], v[228:231], v[20:23]
    v_mfma_f32_16x16x32_bf16 v[24:27], v[204:207], v[232:235], v[24:27]
    v_mfma_f32_16x16x32_bf16 v[28:31], v[204:207], v[236:239], v[28:31]
    v_mfma_f32_16x16x32_bf16 v[32:35], v[208:211], v[224:227], v[32:35]
    v_mfma_f32_16x16x32_bf16 v[36:39], v[208:211], v[228:231], v[36:39]
    v_mfma_f32_16x16x32_bf16 v[40:43], v[208:211], v[232:235], v[40:43]
    v_mfma_f32_16x16x32_bf16 v[44:47], v[208:211], v[236:239], v[44:47]
    s_nop 1
    s_nop 0
    ds_write_b128 v7, v[20:23] offset:0
    ds_write_b128 v7, v[24:27] offset:5120
    ds_write_b128 v7, v[28:31] offset:10240
    v_mfma_f32_16x16x32_bf16 v[48:51], v[212:215], v[224:227], v[48:51]
    v_mfma_f32_16x16x32_bf16 v[52:55], v[212:215], v[228:231], v[52:55]
    v_mfma_f32_16x16x32_bf16 v[56:59], v[212:215], v[232:235], v[56:59]
    v_mfma_f32_16x16x32_bf16 v[60:63], v[212:215], v[236:239], v[60:63]
    ds_write_b128 v7, v[36:39] offset:1024
    ds_write_b128 v7, v[40:43] offset:6144
    ds_write_b128 v7, v[44:47] offset:11264
    v_mfma_f32_16x16x32_bf16 v[64:67], v[216:219], v[224:227], v[64:67]
    v_mfma_f32_16x16x32_bf16 v[68:71], v[216:219], v[228:231], v[68:71]
    v_mfma_f32_16x16x32_bf16 v[72:75], v[216:219], v[232:235], v[72:75]
    v_mfma_f32_16x16x32_bf16 v[76:79], v[216:219], v[236:239], v[76:79]
    ds_write_b128 v7, v[52:55] offset:2048
    ds_write_b128 v7, v[56:59] offset:7168
    ds_write_b128 v7, v[60:63] offset:12288
    v_mfma_f32_16x16x32_bf16 v[80:83], v[220:223], v[224:227], v[80:83]
    v_mfma_f32_16x16x32_bf16 v[84:87], v[220:223], v[228:231], v[84:87]
    v_mfma_f32_16x16x32_bf16 v[88:91], v[220:223], v[232:235], v[88:91]
    v_mfma_f32_16x16x32_bf16 v[92:95], v[220:223], v[236:239], v[92:95]
    ds_write_b128 v7, v[68:71] offset:3072
    ds_write_b128 v7, v[72:75] offset:8192
    ds_write_b128 v7, v[76:79] offset:13312
    s_nop 2
    s_nop 0
    ds_write_b128 v7, v[84:87] offset:4096
    ds_write_b128 v7, v[88:91] offset:9216
    ds_write_b128 v7, v[92:95] offset:14336
    s_waitcnt vmcnt(0)
    v_lshlrev_b32 v96, 16, v240
    v_and_b32 v97, 0xffff0000, v240
    v_pk_add_f32 v[16:17], v[16:17], v[96:97]
    v_lshlrev_b32 v98, 16, v241
    v_and_b32 v99, 0xffff0000, v241
    v_pk_add_f32 v[18:19], v[18:19], v[98:99]
    v_lshlrev_b32 v100, 16, v242
    v_and_b32 v101, 0xffff0000, v242
    v_pk_add_f32 v[32:33], v[32:33], v[100:101]
    v_lshlrev_b32 v102, 16, v243
    v_and_b32 v103, 0xffff0000, v243
    v_pk_add_f32 v[34:35], v[34:35], v[102:103]
    v_lshlrev_b32 v96, 16, v244
    v_and_b32 v97, 0xffff0000, v244
    v_pk_add_f32 v[48:49], v[48:49], v[96:97]
    v_lshlrev_b32 v98, 16, v245
    v_and_b32 v99, 0xffff0000, v245
    v_pk_add_f32 v[50:51], v[50:51], v[98:99]
    v_lshlrev_b32 v100, 16, v246
    v_and_b32 v101, 0xffff0000, v246
    v_pk_add_f32 v[64:65], v[64:65], v[100:101]
    v_lshlrev_b32 v102, 16, v247
    v_and_b32 v103, 0xffff0000, v247
    v_pk_add_f32 v[66:67], v[66:67], v[102:103]
    v_lshlrev_b32 v96, 16, v248
    v_and_b32 v97, 0xffff0000, v248
    v_pk_add_f32 v[80:81], v[80:81], v[96:97]
    v_lshlrev_b32 v98, 16, v249
    v_and_b32 v99, 0xffff0000, v249
    v_pk_add_f32 v[82:83], v[82:83], v[98:99]
    s_waitcnt lgkmcnt(0)
    s_barrier
    s_nop 0
    ds_read_b128 v[96:99], v12 offset:0
    ds_read_b128 v[100:103], v12 offset:1024
    ds_read_b128 v[104:107], v12 offset:2048
    ds_read_b128 v[108:111], v12 offset:3072
    ds_read_b128 v[112:115], v12 offset:4096
    ds_read_b128 v[116:119], v13 offset:0
    ds_read_b128 v[120:123], v13 offset:1024
    ds_read_b128 v[124:127], v13 offset:2048
    ds_read_b128 v[128:131], v13 offset:3072
    ds_read_b128 v[132:135], v13 offset:4096
    ds_read_b128 v[136:139], v14 offset:0
    ds_read_b128 v[140:143], v14 offset:1024
    ds_read_b128 v[144:147], v14 offset:2048
    ds_read_b128 v[148:151], v14 offset:3072
    ds_read_b128 v[152:155], v14 offset:4096
    s_waitcnt lgkmcnt(10)
    s_nop 0
    ds_read_b64_tr_b16 v[156:157], v10 offset:0
    ds_read_b64_tr_b16 v[158:159], v10 offset:512
    ds_read_b64_tr_b16 v[160:161], v10 offset:4096
    ds_read_b64_tr_b16 v[162:163], v10 offset:4608
    ds_read_b64_tr_b16 v[164:165], v11 offset:8192
    s_waitcnt lgkmcnt(15)
    s_nop 0
    v_pk_add_f32 v[16:17], v[16:17], v[96:97]
    v_pk_add_f32 v[18:19], v[18:19], v[98:99]
    v_pk_add_f32 v[32:33], v[32:33], v[100:101]
    v_pk_add_f32 v[34:35], v[34:35], v[102:103]
    v_pk_add_f32 v[48:49], v[48:49], v[104:105]
    v_pk_add_f32 v[50:51], v[50:51], v[106:107]
    v_pk_add_f32 v[64:65], v[64:65], v[108:109]
    v_pk_add_f32 v[66:67], v[66:67], v[110:111]
    v_pk_add_f32 v[80:81], v[80:81], v[112:113]
    v_pk_add_f32 v[82:83], v[82:83], v[114:115]
    s_waitcnt lgkmcnt(10)
    s_nop 0
    v_pk_add_f32 v[16:17], v[16:17], v[116:117]
    v_pk_add_f32 v[18:19], v[18:19], v[118:119]
    v_pk_add_f32 v[32:33], v[32:33], v[120:121]
    v_pk_add_f32 v[34:35], v[34:35], v[122:123]
    v_pk_add_f32 v[48:49], v[48:49], v[124:125]
    v_pk_add_f32 v[50:51], v[50:51], v[126:127]
    v_pk_add_f32 v[64:65], v[64:65], v[128:129]
    v_pk_add_f32 v[66:67], v[66:67], v[130:131]
    v_pk_add_f32 v[80:81], v[80:81], v[132:133]
    v_pk_add_f32 v[82:83], v[82:83], v[134:135]
    s_waitcnt lgkmcnt(5)
    s_nop 0
    v_pk_add_f32 v[16:17], v[16:17], v[136:137]
    v_pk_add_f32 v[18:19], v[18:19], v[138:139]
    v_pk_add_f32 v[32:33], v[32:33], v[140:141]
    v_pk_add_f32 v[34:35], v[34:35], v[142:143]
    v_pk_add_f32 v[48:49], v[48:49], v[144:145]
    v_pk_add_f32 v[50:51], v[50:51], v[146:147]
    v_pk_add_f32 v[64:65], v[64:65], v[148:149]
    v_pk_add_f32 v[66:67], v[66:67], v[150:151]
    v_pk_add_f32 v[80:81], v[80:81], v[152:153]
    v_pk_add_f32 v[82:83], v[82:83], v[154:155]
    s_waitcnt vmcnt(0) lgkmcnt(0)
    v_lshlrev_b32 v98, 16, v156
    v_and_b32 v99, 0xffff0000, v156
    v_pk_add_f32 v[16:17], v[16:17], v[98:99]
    v_cvt_pk_bf16_f32 v240, v16, v17
    v_lshlrev_b32_e64 v102, 16, v157
    v_and_b32 v103, 0xffff0000, v157
    v_pk_add_f32 v[18:19], v[18:19], v[102:103]
    v_cvt_pk_bf16_f32 v241, v18, v19
    v_lshlrev_b32_e64 v106, 16, v158
    v_and_b32 v107, 0xffff0000, v158
    v_pk_add_f32 v[32:33], v[32:33], v[106:107]
    v_cvt_pk_bf16_f32 v242, v32, v33
    v_lshlrev_b32_e64 v110, 16, v159
    v_and_b32 v111, 0xffff0000, v159
    v_pk_add_f32 v[34:35], v[34:35], v[110:111]
    v_cvt_pk_bf16_f32 v243, v34, v35
    buffer_store_dwordx4 v[240:243], v5, s[12:15], s72 offen
    v_lshlrev_b32_e64 v98, 16, v160
    v_and_b32 v99, 0xffff0000, v160
    v_pk_add_f32 v[48:49], v[48:49], v[98:99]
    v_cvt_pk_bf16_f32 v244, v48, v49
    v_lshlrev_b32_e64 v102, 16, v161
    v_and_b32 v103, 0xffff0000, v161
    v_pk_add_f32 v[50:51], v[50:51], v[102:103]
    v_cvt_pk_bf16_f32 v245, v50, v51
    v_lshlrev_b32_e64 v106, 16, v162
    v_and_b32 v107, 0xffff0000, v162
    v_pk_add_f32 v[64:65], v[64:65], v[106:107]
    v_cvt_pk_bf16_f32 v246, v64, v65
    v_lshlrev_b32_e64 v110, 16, v163
    v_and_b32 v111, 0xffff0000, v163
    v_pk_add_f32 v[66:67], v[66:67], v[110:111]
    v_cvt_pk_bf16_f32 v247, v66, v67
    buffer_store_dwordx4 v[244:247], v5, s[12:15], s72 offen offset:64
    v_lshlrev_b32_e64 v98, 16, v164
    v_and_b32 v99, 0xffff0000, v164
    v_pk_add_f32 v[80:81], v[80:81], v[98:99]
    v_cvt_pk_bf16_f32 v248, v80, v81
    v_lshlrev_b32_e64 v102, 16, v165
    v_and_b32 v103, 0xffff0000, v165
    v_pk_add_f32 v[82:83], v[82:83], v[102:103]
    v_cvt_pk_bf16_f32 v249, v82, v83
    buffer_store_dwordx2 v[248:249], v6, s[12:15], s72 offen offset:128
L2end:
    s_endpgm
.section .rodata,"a"
.p2align 6
.amdhsa_kernel k2_kernel
  .amdhsa_next_free_vgpr 256
  .amdhsa_next_free_sgpr 102
  .amdhsa_accum_offset 256
  .amdhsa_group_segment_fixed_size 0
  .amdhsa_kernarg_size 112
  .amdhsa_user_sgpr_count 2
  .amdhsa_user_sgpr_kernarg_segment_ptr 1
  .amdhsa_system_sgpr_workgroup_id_x 1
.end_amdhsa_kernel
```
